```python
import torch

def _softmax(x, axis=-1):
    return torch.softmax(x, dim=axis)
def _gelu(x):
    return torch.nn.functional.gelu(x, approximate="tanh")
def _silu(x):
    return torch.nn.functional.silu(x)
def _sigmoid(x):
    return torch.sigmoid(x)
def _layernorm(x, axis=-1, eps=1e-5):
    m = x.mean(dim=axis, keepdim=True)
    v = x.var(dim=axis, keepdim=True, unbiased=False)
    return (x - m) / torch.sqrt(v + eps)
def _scatter_add(tgt, idx, src, axis=0):
    return tgt.clone().index_add_(axis, idx, src)
def _segment_sum(src, seg, n):
    out = torch.zeros((n,) + src.shape[1:], dtype=src.dtype)
    return out.index_add_(0, seg, src)
def _pad(x, pw):
    flat = tuple(v for pair in reversed(pw) for v in pair)
    return torch.nn.functional.pad(x, flat)

kernel_name = 'gated_mix__mha_block__ssm_conv_h3__prompt'

def setup_inputs():

    _w = (lambda a: (lambda t: t.to(torch.bfloat16) if t.is_floating_point() else t)(torch.as_tensor(a)))
    def _A_setup():
        B, S, D, H = 1, 2048, 512, 32
        return {
            "x": _w((lambda *s: torch.randn(*s, dtype=torch.bfloat16) * 0.05)(B, S, D)),
            "wqkv": _w((lambda *s: torch.randn(*s, dtype=torch.bfloat16) * 0.8)(D, 3 * D)),
            "wo": _w((lambda *s: torch.randn(*s, dtype=torch.bfloat16) * 0.05)(D, D)),
        }
    _A_in = _A_setup()

    def _B_setup():
        B, S, D = 1, 2048, 512
        ks = 4
        return {
            "q": _w((lambda *s: torch.randn(*s, dtype=torch.bfloat16) * 0.05)(B, S, D)),
            "k": _w((lambda *s: torch.randn(*s, dtype=torch.bfloat16) * 0.4)(B, S, D)),
            "v": _w((lambda *s: torch.randn(*s, dtype=torch.bfloat16) * 0.4)(B, S, D)),
            "shift_k": _w((lambda *s: torch.randn(*s, dtype=torch.bfloat16) * 0.4)(D, ks) * 0.5),
            "ssm_k": _w((lambda *s: torch.randn(*s, dtype=torch.bfloat16) * 1.6)(D, S) * (1.0 / S ** 0.5)),
            "ssm_D": _w((lambda *s: torch.randn(*s, dtype=torch.bfloat16) * 0.4)(D)),
        }
    _B_in = _B_setup()

    return {
        "A_x": _A_in["x"],
        "A_wqkv": _A_in["wqkv"],
        "A_wo": _A_in["wo"],
        "B_q": _B_in["q"],
        "B_k": _B_in["k"],
        "B_v": _B_in["v"],
        "B_shift_k": _B_in["shift_k"],
        "B_ssm_k": _B_in["ssm_k"],
        "B_ssm_D": _B_in["ssm_D"],
        "gate_w": _w((lambda *s: torch.randn(*s, dtype=torch.bfloat16) * 0.05)(512) * 16.0),
    }

def reference(A_x, A_wqkv, A_wo, B_q, B_k, B_v, B_shift_k, B_ssm_k, B_ssm_D, gate_w):
    def _A_ref(x, wqkv, wo):
        B, S, D = x.shape
        H = 32
        Dh = D // H
        qkv = (lambda x, *d: x.permute(*d))((x @ wqkv).reshape(B, S, 3, H, Dh), 2, 0, 3, 1, 4)
        q, k, v = qkv[0], qkv[1], qkv[2]
        scores = torch.einsum("bhqd,bhkd->bhqk", q, k) * (Dh ** -0.5)
        p = _softmax(scores, axis=-1)
        o = torch.einsum("bhqk,bhkd->bhqd", p, v)
        return (lambda x, *d: x.permute(*d))(o, 0, 2, 1, 3).reshape(B, S, D) @ wo

    def _B_ref(q, k, v, shift_k, ssm_k, ssm_D):
        B, S, D = q.shape
        ks = shift_k.shape[-1]
        k_pad = _pad(k, ((0, 0), (ks - 1, 0), (0, 0)))
        k_shift = torch.zeros_like(k)
        for t in range(ks):
            k_shift = k_shift + k_pad[:, t:t + S, :] * shift_k[:, ks - 1 - t][None, None, :]
        kv = k_shift * v
        L = 2 * S
        kv_pad = _pad(kv, ((0, 0), (0, S), (0, 0)))
        kf_pad = _pad(ssm_k, ((0, 0), (0, S)))
        kv_f = (lambda x, axes=(-2,-1): torch.fft.rfft2(x.float(), dim=axes))(kv_pad[:, None, :, :], axes=(1, 2))
        kf_f = (lambda x, axes=(-2,-1): torch.fft.rfft2(x.float(), dim=axes))(kf_pad[:, None, :], axes=(1, 2))
        kf_f = (lambda x, *d: x.permute(*d))(kf_f, 1, 2, 0)
        y_f = kv_f * kf_f[None, :, :, :]
        y = (lambda x, s, axes=(-2,-1): torch.fft.irfft2(x, s=s, dim=axes).to(torch.bfloat16))(y_f, (1, L), axes=(1, 2))[:, 0, :S, :]
        y = y + kv * ssm_D[None, None, :]
        return q * y

    x = A_x
    g = _sigmoid((x * gate_w).sum(-1, keepdims=True))
    a = _A_ref(x, A_wqkv, A_wo)
    b = _B_ref(x, B_k, B_v, B_shift_k, B_ssm_k, B_ssm_D)
    return g * a + (1 - g) * b
```

```asm
; @launch grid=(256,1,1) block=(512,1,1) lds=163840
.amdgcn_target "amdgcn-amd-amdhsa--gfx950"
.text
.globl gated_mix__mha_block__ssm_conv_h3__prompt_kernel
.p2align 8
.type gated_mix__mha_block__ssm_conv_h3__prompt_kernel,@function
gated_mix__mha_block__ssm_conv_h3__prompt_kernel:
    s_cmp_ge_u32 s2, 256
    s_cbranch_scc1 L_end
    s_load_dwordx16 s[16:31], s[0:1], 0
    s_load_dwordx8 s[32:39], s[0:1], 64
    s_load_dwordx2 s[40:41], s[0:1], 96
    v_lshrrev_b32 v1, 6, v0
    s_nop 0
    v_readfirstlane_b32 s3, v1
    v_and_b32 v1, 63, v0
    s_bfe_u32 s8, s2, 0x20001
    s_bfe_u32 s9, s2, 0x20003
    s_lshl_b32 s5, s8, 2
    s_add_u32 s5, s5, s9
    s_and_b32 s8, s2, 1
    s_lshr_b32 s10, s2, 5
    s_lshl_b32 s4, s8, 3
    s_add_u32 s4, s4, s10
    s_lshl_b32 s9, s9, 1
    s_add_u32 s81, s10, s9
    s_lshl_b32 s80, s4, 4
    s_add_u32 s80, s80, s5
    s_and_b32 s6, s2, 7
    s_lshr_b32 s7, s2, 3
    s_and_b32 s15, s3, 3
    v_mov_b32 v2, 15073280
    s_cmp_lg_u32 s3, 7
    s_cbranch_scc1 L_nocpf
    s_getpc_b64 s[8:9]
L_pc:
    s_mul_hi_u32 s10, s7, 0x55555556
    s_mul_i32 s10, s10, 3
    s_sub_u32 s10, s7, s10
    s_lshl_b32 s10, s10, 13
    v_lshl_add_u32 v8, v1, 7, s10
    v_min_u32 v8, L_last - L_pc, v8
    v_mov_b32 v9, s9
    v_add_co_u32 v8, vcc, s8, v8
    s_nop 1
    v_addc_co_u32 v9, vcc, 0, v9, vcc
    global_load_dword v253, v[8:9], off
L_nocpf:
    s_lshr_b32 s10, s2, 5
    s_and_b32 s10, s10, 1
    s_sub_u32 s81, s81, s10
    s_cmp_ge_u32 s3, 4
    s_cbranch_scc1 L_vrole
    s_lshl_b32 s8, s7, 2
    s_add_u32 s8, s8, s3
    s_lshl_b32 s8, s8, 14
    s_lshl_b32 s9, s6, 7
    s_add_u32 s8, s8, s9
    v_lshrrev_b32 v54, 3, v1
    v_and_b32 v55, 7, v1
    v_lshlrev_b32 v55, 4, v55
    v_lshl_add_u32 v54, v54, 10, v55
    v_add_u32 v54, s8, v54
    v_add_u32 v53, 0xffffe000, v54
    v_add_u32 v55, 0x2000, v54
    s_mul_i32 s12, s3, 5120
    s_add_u32 s12, s12, 123904
    v_and_b32 v49, 31, v1
    s_lshl_b32 s9, s6, 9
    v_lshl_add_u32 v6, v49, 4, s9
    s_waitcnt lgkmcnt(0)
    s_mov_b32 s60, s28
    s_mov_b32 s61, s29
    s_mov_b32 s62, 4096
    s_mov_b32 s63, 0x20000
    buffer_load_dwordx4 v[32:35], v6, s[60:63], 0 offen
    s_mov_b32 s52, s24
    s_mov_b32 s53, s25
    s_mov_b32 s54, 2097152
    s_mov_b32 s55, 0x20000
    s_mov_b32 s56, s26
    s_mov_b32 s57, s27
    s_mov_b32 s58, 2097152
    s_mov_b32 s59, 0x20000
    s_add_u32 m0, s12, 0
    s_nop 0
    buffer_load_dwordx4 v53, s[52:55], 0 offen lds
    s_add_u32 m0, s12, 1024
    s_nop 0
    buffer_load_dwordx4 v54, s[52:55], 0 offen lds
    s_add_u32 m0, s12, 2048
    s_nop 0
    buffer_load_dwordx4 v55, s[52:55], 0 offen lds
    s_add_u32 m0, s12, 3072
    s_nop 0
    buffer_load_dwordx4 v54, s[56:59], 0 offen lds
    s_add_u32 m0, s12, 4096
    s_nop 0
    buffer_load_dwordx4 v55, s[56:59], 0 offen lds
    s_mov_b32 s44, s16
    s_mov_b32 s45, s17
    s_mov_b32 s46, 2097152
    s_mov_b32 s47, 0x20000
    s_add_u32 s40, s40, 0xfffff
    s_addc_u32 s41, s41, 0
    s_and_b32 s40, s40, 0xfff00000
    s_mov_b32 s68, s40
    s_mov_b32 s69, s41
    s_mov_b32 s70, 20971520
    s_mov_b32 s71, 0x20000
    buffer_load_dword v254, v2, s[68:71], 0 offen sc0 sc1
    v_and_b32 v56, 31, v1
    v_lshrrev_b32 v57, 5, v1
    v_bfe_u32 v58, v1, 1, 3
    v_xor_b32 v58, v58, v57
    v_lshlrev_b32 v58, 4, v58
    v_lshl_add_u32 v58, v56, 7, v58
    s_lshl_b32 s8, s15, 12
    v_add_u32 v128, s8, v58
    v_xor_b32 v129, 32, v128
    v_xor_b32 v130, 64, v128
    v_xor_b32 v131, 0x60, v128
    v_bfe_u32 v58, v1, 2, 2
    v_lshl_add_u32 v58, v57, 3, v58
    v_lshlrev_b32 v58, 6, v58
    v_bfe_u32 v59, v1, 4, 1
    v_lshl_add_u32 v58, v59, 5, v58
    v_and_b32 v59, 3, v1
    v_lshl_add_u32 v58, v59, 3, v58
    v_add_u32 v132, 0x4000, v58
    v_add_u32 v133, 57344, v128
    v_add_u32 v134, 57344, v129
    v_add_u32 v135, 57344, v130
    v_add_u32 v136, 57344, v131
    v_add_u32 v137, 57344, v132
    v_and_b32 v8, 7, v1
    v_lshlrev_b32 v8, 2, v8
    v_add_u32 v8, 163776, v8
    v_mov_b32 v9, 0
    ds_write_b32 v8, v9
    s_waitcnt vmcnt(1)
    v_lshrrev_b32 v48, 5, v0
    v_lshrrev_b32 v53, 5, v1
    v_lshlrev_b32 v53, 10, v53
    v_lshl_add_u32 v53, v49, 2, v53
    v_add_u32 v53, s12, v53
    ds_read_b32 v8, v53 offset:640
    ds_read_b32 v9, v53 offset:768
    ds_read_b32 v10, v53 offset:896
    ds_read_b32 v11, v53 offset:1024
    ds_read_b32 v12, v53 offset:1152
    ds_read_b32 v13, v53 offset:1280
    ds_read_b32 v14, v53 offset:1408
    ds_read_b32 v15, v53 offset:1536
    ds_read_b32 v16, v53 offset:1664
    ds_read_b32 v17, v53 offset:1792
    ds_read_b32 v18, v53 offset:1920
    v_mul_u32_u24 v50, 288, v49
    v_lshlrev_b32 v48, 4, v48
    v_sub_u32 v50, v50, v48
    v_add_u32 v50, 114800, v50
    v_lshlrev_b32 v182, 16, v32
    v_lshlrev_b32 v183, 16, v34
    v_and_b32 v184, 0xffff0000, v32
    v_and_b32 v185, 0xffff0000, v34
    v_lshlrev_b32 v186, 16, v33
    v_lshlrev_b32 v187, 16, v35
    v_and_b32 v188, 0xffff0000, v33
    v_and_b32 v189, 0xffff0000, v35
    s_waitcnt lgkmcnt(7)
    v_lshlrev_b32 v144, 16, v8
    v_and_b32 v145, 0xffff0000, v8
    v_lshlrev_b32 v146, 16, v9
    v_and_b32 v147, 0xffff0000, v9
    v_lshlrev_b32 v148, 16, v10
    v_and_b32 v149, 0xffff0000, v10
    v_lshlrev_b32 v150, 16, v11
    v_and_b32 v151, 0xffff0000, v11
    s_waitcnt lgkmcnt(3)
    ds_read_b32 v20, v53 offset:3072
    ds_read_b32 v21, v53 offset:3200
    ds_read_b32 v22, v53 offset:3328
    ds_read_b32 v23, v53 offset:3456
    ds_read_b32 v24, v53 offset:3584
    ds_read_b32 v25, v53 offset:3712
    ds_read_b32 v26, v53 offset:3840
    ds_read_b32 v27, v53 offset:3968
    v_lshlrev_b32 v152, 16, v12
    v_and_b32 v153, 0xffff0000, v12
    v_lshlrev_b32 v154, 16, v13
    v_and_b32 v155, 0xffff0000, v13
    v_lshlrev_b32 v156, 16, v14
    v_and_b32 v157, 0xffff0000, v14
    v_lshlrev_b32 v158, 16, v15
    v_and_b32 v159, 0xffff0000, v15
    s_waitcnt lgkmcnt(8)
    v_lshlrev_b32 v160, 16, v16
    v_and_b32 v161, 0xffff0000, v16
    v_lshlrev_b32 v162, 16, v17
    v_and_b32 v163, 0xffff0000, v17
    v_lshlrev_b32 v164, 16, v18
    v_and_b32 v165, 0xffff0000, v18
    v_pk_mul_f32 v[190:191], v[144:145], v[188:189]
    v_pk_mul_f32 v[192:193], v[146:147], v[188:189]
    v_pk_mul_f32 v[194:195], v[148:149], v[188:189]
    v_pk_mul_f32 v[196:197], v[150:151], v[188:189]
    v_pk_mul_f32 v[198:199], v[152:153], v[188:189]
    v_pk_mul_f32 v[200:201], v[154:155], v[188:189]
    v_pk_mul_f32 v[202:203], v[156:157], v[188:189]
    v_pk_mul_f32 v[204:205], v[158:159], v[188:189]
    v_pk_fma_f32 v[190:191], v[146:147], v[186:187], v[190:191]
    v_pk_fma_f32 v[192:193], v[148:149], v[186:187], v[192:193]
    v_pk_fma_f32 v[194:195], v[150:151], v[186:187], v[194:195]
    v_pk_fma_f32 v[196:197], v[152:153], v[186:187], v[196:197]
    v_pk_fma_f32 v[198:199], v[154:155], v[186:187], v[198:199]
    v_pk_fma_f32 v[200:201], v[156:157], v[186:187], v[200:201]
    v_pk_fma_f32 v[202:203], v[158:159], v[186:187], v[202:203]
    v_pk_fma_f32 v[204:205], v[160:161], v[186:187], v[204:205]
    v_pk_fma_f32 v[190:191], v[148:149], v[184:185], v[190:191]
    v_pk_fma_f32 v[192:193], v[150:151], v[184:185], v[192:193]
    v_pk_fma_f32 v[194:195], v[152:153], v[184:185], v[194:195]
    v_pk_fma_f32 v[196:197], v[154:155], v[184:185], v[196:197]
    v_pk_fma_f32 v[198:199], v[156:157], v[184:185], v[198:199]
    v_pk_fma_f32 v[200:201], v[158:159], v[184:185], v[200:201]
    v_pk_fma_f32 v[202:203], v[160:161], v[184:185], v[202:203]
    v_pk_fma_f32 v[204:205], v[162:163], v[184:185], v[204:205]
    v_pk_fma_f32 v[190:191], v[150:151], v[182:183], v[190:191]
    v_pk_fma_f32 v[192:193], v[152:153], v[182:183], v[192:193]
    v_pk_fma_f32 v[194:195], v[154:155], v[182:183], v[194:195]
    v_pk_fma_f32 v[196:197], v[156:157], v[182:183], v[196:197]
    v_pk_fma_f32 v[198:199], v[158:159], v[182:183], v[198:199]
    v_pk_fma_f32 v[200:201], v[160:161], v[182:183], v[200:201]
    v_pk_fma_f32 v[202:203], v[162:163], v[182:183], v[202:203]
    v_pk_fma_f32 v[204:205], v[164:165], v[182:183], v[204:205]
    s_waitcnt lgkmcnt(0)
    v_lshlrev_b32 v166, 16, v20
    v_and_b32 v167, 0xffff0000, v20
    v_lshlrev_b32 v168, 16, v21
    v_and_b32 v169, 0xffff0000, v21
    v_lshlrev_b32 v170, 16, v22
    v_and_b32 v171, 0xffff0000, v22
    v_lshlrev_b32 v172, 16, v23
    v_and_b32 v173, 0xffff0000, v23
    v_lshlrev_b32 v174, 16, v24
    v_and_b32 v175, 0xffff0000, v24
    v_lshlrev_b32 v176, 16, v25
    v_and_b32 v177, 0xffff0000, v25
    v_lshlrev_b32 v178, 16, v26
    v_and_b32 v179, 0xffff0000, v26
    v_lshlrev_b32 v180, 16, v27
    v_and_b32 v181, 0xffff0000, v27
    v_pk_mul_f32 v[190:191], v[190:191], v[166:167]
    v_pk_mul_f32 v[192:193], v[192:193], v[168:169]
    v_pk_mul_f32 v[194:195], v[194:195], v[170:171]
    v_pk_mul_f32 v[196:197], v[196:197], v[172:173]
    v_pk_mul_f32 v[198:199], v[198:199], v[174:175]
    v_pk_mul_f32 v[200:201], v[200:201], v[176:177]
    v_pk_mul_f32 v[202:203], v[202:203], v[178:179]
    v_pk_mul_f32 v[204:205], v[204:205], v[180:181]
    v_cvt_pk_bf16_f32 v144, v204, v202
    v_cvt_pk_bf16_f32 v145, v200, v198
    v_cvt_pk_bf16_f32 v146, v196, v194
    v_cvt_pk_bf16_f32 v147, v192, v190
    ds_write_b128 v50, v[144:147] offset:0
    v_cvt_pk_bf16_f32 v148, v205, v203
    v_cvt_pk_bf16_f32 v149, v201, v199
    v_cvt_pk_bf16_f32 v150, v197, v195
    v_cvt_pk_bf16_f32 v151, v193, v191
    ds_write_b128 v50, v[148:151] offset:144
    v_lshrrev_b32 v48, 3, v0
    v_and_b32 v52, 7, v0
    v_lshlrev_b32 v52, 4, v52
    v_mul_u32_u24 v51, 144, v48
    v_add_u32 v51, v51, v52
    v_add_u32 v51, 114688, v51
    v_mul_u32_u24 v48, 4352, v48
    v_add_u32 v52, v48, v52
    s_mul_i32 s13, s6, 278528
    s_lshl_b32 s11, s7, 7
    s_sub_u32 s13, s13, s11
    s_add_u32 s13, s13, 16781184
    s_waitcnt vmcnt(0)
    v_readfirstlane_b32 s43, v254
    s_nop 1
    s_mul_i32 s43, s43, 0x9e3779b1
    s_add_u32 s43, s43, 0x7f4a7c15
    v_lshlrev_b32 v245, 4, v1
    v_lshrrev_b32 v60, 5, v1
    v_lshlrev_b32 v60, 4, v60
    v_and_or_b32 v60, v1, 15, v60
    v_lshlrev_b32 v60, 4, v60
    s_lshl_b32 s10, s3, 11
    v_add_u32 v68, s10, v245
    v_add_u32 v69, s10, v60
    v_and_b32 v61, 27, v1
    v_cmp_eq_u32 vcc, 16, v61
    v_mov_b32 v61, 0x3f803f80
    v_mov_b32 v62, 1040
    v_cndmask_b32 v61, 0, v61, vcc
    v_mov_b32 v63, 1024
    v_cndmask_b32 v246, v62, v63, vcc
    v_add_u32 v247, 0xfffffe00, v246
    v_and_b32 v62, 16, v1
    v_cmp_eq_u32 vcc, 0, v62
    v_mov_b32 v244, 0xdddddddd
    s_mul_i32 s10, s3, 2176
    v_cndmask_b32 v246, v246, v60, vcc
    v_cndmask_b32 v247, v247, v60, vcc
    s_lshl_b32 s11, s80, 15
    s_add_u32 s88, s10, s11
    s_add_u32 s88, s88, s40
    s_addc_u32 s39, s41, 0
    s_mov_b32 s89, 0
    v_mov_b32 v212, v61
    v_mov_b32 v213, v61
    v_mov_b32 v214, v61
    v_mov_b32 v215, v61
    v_mov_b32 v216, v61
    v_mov_b32 v217, v61
    v_mov_b32 v218, v61
    v_mov_b32 v219, v61
    s_lshr_b32 s10, s3, 2
    s_lshl_b32 s10, s10, 12
    s_add_u32 s10, s10, 147968
    s_add_u32 s11, s15, 0
    s_and_b32 s11, s11, 3
    s_lshl_b32 s11, s11, 10
    s_add_u32 s11, s11, s10
    v_add_u32 v64, s11, v245
    s_add_u32 s11, s15, 1
    s_and_b32 s11, s11, 3
    s_lshl_b32 s11, s11, 10
    s_add_u32 s11, s11, s10
    v_add_u32 v65, s11, v245
    s_add_u32 s11, s15, 2
    s_and_b32 s11, s11, 3
    s_lshl_b32 s11, s11, 10
    s_add_u32 s11, s11, s10
    v_add_u32 v66, s11, v245
    s_add_u32 s11, s15, 3
    s_and_b32 s11, s11, 3
    s_lshl_b32 s11, s11, 10
    s_add_u32 s11, s11, s10
    v_add_u32 v67, s11, v245
    v_and_b32 v70, 3, v1
    v_lshlrev_b32 v70, 2, v70
    v_add_u32 v70, 156160, v70
    s_lshl_b32 s10, s2, 2
    s_load_dword s42, s[32:33], s10
    v_and_b32 v60, 3, v1
    v_mul_u32_u24 v248, 4160, v60
    v_bfe_u32 v60, v1, 2, 2
    v_lshrrev_b32 v61, 4, v1
    v_add_u32 v60, v60, v61
    v_lshl_add_u32 v248, v60, 4, v248
    s_lshr_b32 s8, s15, 1
    s_and_b32 s9, s3, 1
    s_lshl_b32 s9, s9, 8
    s_mul_i32 s10, s8, 16640
    s_add_u32 s10, s10, s9
    s_add_u32 s10, s10, 114688
    v_add_u32 v248, s10, v248
    v_and_b32 v60, 1, v1
    v_mul_u32_u24 v249, 4576, v60
    v_lshl_add_u32 v249, v61, 4, v249
    v_bfe_u32 v60, v1, 1, 3
    v_lshlrev_b32 v60, 6, v60
    v_sub_u32 v249, v249, v60
    v_add_u32 v250, 4080, v249
    v_lshlrev_b32 v62, 5, v61
    v_sub_u32 v250, v250, v62
    s_lshl_b32 s11, s3, 9
    v_subrev_u32 v250, s11, v250
    s_mul_i32 s10, s8, 9152
    s_add_u32 s10, s10, s9
    s_add_u32 s10, s10, 448
    v_add_u32 v249, s10, v249
    s_mov_b32 s48, s20
    s_mov_b32 s49, s21
    s_mov_b32 s50, 524288
    s_mov_b32 s51, 0x20000
    s_lshr_b32 s8, s2, 5
    s_lshl_b32 s8, s8, 3
    s_and_b32 s84, s2, 7
    s_add_u32 s84, s84, s8
    s_bfe_u32 s85, s2, 0x20003
    v_and_b32 v29, 31, v1
    v_lshlrev_b32 v29, 10, v29
    s_lshr_b32 s92, s2, 5
    s_lshl_b32 s92, s92, 7
    s_add_u32 s92, s92, 14778368
    s_lshr_b32 s8, s15, 1
    s_lshl_b32 s94, s2, 1
    s_add_u32 s94, s94, s8
    s_mul_i32 s94, s94, 4352
    s_and_b32 s8, s15, 1
    s_lshl_b32 s8, s8, 1
    s_sub_u32 s94, s94, s8
    s_add_u32 s94, s94, 16777218
    s_waitcnt lgkmcnt(0)
    s_barrier
    ds_read_b128 v[8:11], v51
    ds_read_b128 v[12:15], v51 offset:4608
    ds_read_b128 v[144:147], v128 offset:0
    ds_read_b64_tr_b16 v[148:149], v132 offset:0
    ds_read_b64_tr_b16 v[150:151], v132 offset:256
    ds_read_b64_tr_b16 v[152:153], v132 offset:1024
    ds_read_b64_tr_b16 v[154:155], v132 offset:1280
    ds_read_b128 v[156:159], v129 offset:0
    ds_read_b64_tr_b16 v[160:161], v132 offset:3072
    ds_read_b64_tr_b16 v[162:163], v132 offset:3328
    ds_read_b64_tr_b16 v[164:165], v132 offset:4096
    ds_read_b64_tr_b16 v[166:167], v132 offset:4352
    ds_read_b128 v[168:171], v130 offset:0
    ds_read_b64_tr_b16 v[172:173], v132 offset:6144
    ds_read_b64_tr_b16 v[174:175], v132 offset:6400
    ds_read_b64_tr_b16 v[176:177], v132 offset:7168
    ds_read_b64_tr_b16 v[178:179], v132 offset:7424
    s_waitcnt lgkmcnt(10)
    v_mfma_f32_32x32x16_bf16 v[96:111], v[148:151], v[144:147], 0
    v_mfma_f32_32x32x16_bf16 v[112:127], v[152:155], v[144:147], 0
    ds_read_b128 v[180:183], v131 offset:0
    ds_read_b64_tr_b16 v[184:185], v132 offset:9216
    ds_read_b64_tr_b16 v[186:187], v132 offset:9472
    ds_read_b64_tr_b16 v[188:189], v132 offset:10240
    ds_read_b64_tr_b16 v[190:191], v132 offset:10496
    s_waitcnt lgkmcnt(10)
    v_mfma_f32_32x32x16_bf16 v[96:111], v[160:163], v[156:159], v[96:111]
    v_mfma_f32_32x32x16_bf16 v[112:127], v[164:167], v[156:159], v[112:127]
    s_add_u32 s9, s13, 139264
    buffer_store_dwordx4 v[8:11], v52, s[68:71], s13 offen sc1
    buffer_store_dwordx4 v[12:15], v52, s[68:71], s9 offen sc1
    s_barrier
    ds_read_b128 v[144:147], v128 offset:28672
    ds_read_b64_tr_b16 v[148:149], v132 offset:28672
    ds_read_b64_tr_b16 v[150:151], v132 offset:28928
    ds_read_b64_tr_b16 v[152:153], v132 offset:29696
    ds_read_b64_tr_b16 v[154:155], v132 offset:29952
    s_waitcnt lgkmcnt(10)
    v_mfma_f32_32x32x16_bf16 v[96:111], v[172:175], v[168:171], v[96:111]
    v_mfma_f32_32x32x16_bf16 v[112:127], v[176:179], v[168:171], v[112:127]
    ds_read_b128 v[156:159], v129 offset:28672
    ds_read_b64_tr_b16 v[160:161], v132 offset:31744
    ds_read_b64_tr_b16 v[162:163], v132 offset:32000
    ds_read_b64_tr_b16 v[164:165], v132 offset:32768
    ds_read_b64_tr_b16 v[166:167], v132 offset:33024
    s_waitcnt lgkmcnt(10)
    v_mfma_f32_32x32x16_bf16 v[96:111], v[184:187], v[180:183], v[96:111]
    v_mfma_f32_32x32x16_bf16 v[112:127], v[188:191], v[180:183], v[112:127]
    ds_read_b128 v[168:171], v130 offset:28672
    ds_read_b64_tr_b16 v[172:173], v132 offset:34816
    ds_read_b64_tr_b16 v[174:175], v132 offset:35072
    ds_read_b64_tr_b16 v[176:177], v132 offset:35840
    ds_read_b64_tr_b16 v[178:179], v132 offset:36096
    s_waitcnt lgkmcnt(10)
    v_mfma_f32_32x32x16_bf16 v[96:111], v[148:151], v[144:147], v[96:111]
    v_mfma_f32_32x32x16_bf16 v[112:127], v[152:155], v[144:147], v[112:127]
    ds_read_b128 v[180:183], v131 offset:28672
    ds_read_b64_tr_b16 v[184:185], v132 offset:37888
    ds_read_b64_tr_b16 v[186:187], v132 offset:38144
    ds_read_b64_tr_b16 v[188:189], v132 offset:38912
    ds_read_b64_tr_b16 v[190:191], v132 offset:39168
    s_waitcnt lgkmcnt(10)
    v_mfma_f32_32x32x16_bf16 v[96:111], v[160:163], v[156:159], v[96:111]
    v_mfma_f32_32x32x16_bf16 v[112:127], v[164:167], v[156:159], v[112:127]
    s_barrier
    ds_read_b128 v[144:147], v133 offset:0
    ds_read_b64_tr_b16 v[148:149], v137 offset:0
    ds_read_b64_tr_b16 v[150:151], v137 offset:256
    ds_read_b64_tr_b16 v[152:153], v137 offset:1024
    ds_read_b64_tr_b16 v[154:155], v137 offset:1280
    s_waitcnt lgkmcnt(10)
    v_mfma_f32_32x32x16_bf16 v[96:111], v[172:175], v[168:171], v[96:111]
    v_mfma_f32_32x32x16_bf16 v[112:127], v[176:179], v[168:171], v[112:127]
    ds_read_b128 v[156:159], v134 offset:0
    ds_read_b64_tr_b16 v[160:161], v137 offset:3072
    ds_read_b64_tr_b16 v[162:163], v137 offset:3328
    ds_read_b64_tr_b16 v[164:165], v137 offset:4096
    ds_read_b64_tr_b16 v[166:167], v137 offset:4352
    s_waitcnt lgkmcnt(10)
    v_mfma_f32_32x32x16_bf16 v[96:111], v[184:187], v[180:183], v[96:111]
    v_mfma_f32_32x32x16_bf16 v[112:127], v[188:191], v[180:183], v[112:127]
    ds_read_b128 v[168:171], v135 offset:0
    ds_read_b64_tr_b16 v[172:173], v137 offset:6144
    ds_read_b64_tr_b16 v[174:175], v137 offset:6400
    ds_read_b64_tr_b16 v[176:177], v137 offset:7168
    ds_read_b64_tr_b16 v[178:179], v137 offset:7424
    s_waitcnt lgkmcnt(10)
    v_mfma_f32_32x32x16_bf16 v[96:111], v[148:151], v[144:147], v[96:111]
    v_mfma_f32_32x32x16_bf16 v[112:127], v[152:155], v[144:147], v[112:127]
    ds_read_b128 v[180:183], v136 offset:0
    ds_read_b64_tr_b16 v[184:185], v137 offset:9216
    ds_read_b64_tr_b16 v[186:187], v137 offset:9472
    ds_read_b64_tr_b16 v[188:189], v137 offset:10240
    ds_read_b64_tr_b16 v[190:191], v137 offset:10496
    s_waitcnt lgkmcnt(10)
    v_mfma_f32_32x32x16_bf16 v[96:111], v[160:163], v[156:159], v[96:111]
    v_mfma_f32_32x32x16_bf16 v[112:127], v[164:167], v[156:159], v[112:127]
    s_waitcnt vmcnt(0)
    s_barrier
    s_cmp_lg_u32 s3, 0
    s_cbranch_scc1 L_nofl18000
    s_lshl_b32 s8, s2, 7
    s_add_u32 s8, s8, 14778368
    v_mov_b32 v8, s43
    v_mov_b32 v2, 0
    s_lshl_b64 exec, 1, 63
    buffer_store_dword v8, v2, s[68:71], s8 offen sc1
    s_mov_b64 exec, -1
L_nofl18000:
    ds_read_b128 v[144:147], v133 offset:28672
    ds_read_b64_tr_b16 v[148:149], v137 offset:28672
    ds_read_b64_tr_b16 v[150:151], v137 offset:28928
    ds_read_b64_tr_b16 v[152:153], v137 offset:29696
    ds_read_b64_tr_b16 v[154:155], v137 offset:29952
    s_waitcnt lgkmcnt(10)
    v_mfma_f32_32x32x16_bf16 v[96:111], v[172:175], v[168:171], v[96:111]
    v_mfma_f32_32x32x16_bf16 v[112:127], v[176:179], v[168:171], v[112:127]
    ds_read_b128 v[156:159], v134 offset:28672
    ds_read_b64_tr_b16 v[160:161], v137 offset:31744
    ds_read_b64_tr_b16 v[162:163], v137 offset:32000
    ds_read_b64_tr_b16 v[164:165], v137 offset:32768
    ds_read_b64_tr_b16 v[166:167], v137 offset:33024
    s_waitcnt lgkmcnt(10)
    v_mfma_f32_32x32x16_bf16 v[96:111], v[184:187], v[180:183], v[96:111]
    v_mfma_f32_32x32x16_bf16 v[112:127], v[188:191], v[180:183], v[112:127]
    ds_read_b128 v[168:171], v135 offset:28672
    ds_read_b64_tr_b16 v[172:173], v137 offset:34816
    ds_read_b64_tr_b16 v[174:175], v137 offset:35072
    ds_read_b64_tr_b16 v[176:177], v137 offset:35840
    ds_read_b64_tr_b16 v[178:179], v137 offset:36096
    s_waitcnt lgkmcnt(10)
    v_mfma_f32_32x32x16_bf16 v[96:111], v[148:151], v[144:147], v[96:111]
    v_mfma_f32_32x32x16_bf16 v[112:127], v[152:155], v[144:147], v[112:127]
    ds_read_b128 v[180:183], v136 offset:28672
    ds_read_b64_tr_b16 v[184:185], v137 offset:37888
    ds_read_b64_tr_b16 v[186:187], v137 offset:38144
    ds_read_b64_tr_b16 v[188:189], v137 offset:38912
    ds_read_b64_tr_b16 v[190:191], v137 offset:39168
    s_waitcnt lgkmcnt(10)
    v_mfma_f32_32x32x16_bf16 v[96:111], v[160:163], v[156:159], v[96:111]
    v_mfma_f32_32x32x16_bf16 v[112:127], v[164:167], v[156:159], v[112:127]
    s_barrier
    ds_read_b128 v[144:147], v128 offset:0
    ds_read_b64_tr_b16 v[148:149], v132 offset:0
    ds_read_b64_tr_b16 v[150:151], v132 offset:256
    ds_read_b64_tr_b16 v[152:153], v132 offset:1024
    ds_read_b64_tr_b16 v[154:155], v132 offset:1280
    s_waitcnt lgkmcnt(10)
    v_mfma_f32_32x32x16_bf16 v[96:111], v[172:175], v[168:171], v[96:111]
    v_mfma_f32_32x32x16_bf16 v[112:127], v[176:179], v[168:171], v[112:127]
    ds_read_b128 v[156:159], v129 offset:0
    ds_read_b64_tr_b16 v[160:161], v132 offset:3072
    ds_read_b64_tr_b16 v[162:163], v132 offset:3328
    ds_read_b64_tr_b16 v[164:165], v132 offset:4096
    ds_read_b64_tr_b16 v[166:167], v132 offset:4352
    s_waitcnt lgkmcnt(10)
    v_mfma_f32_32x32x16_bf16 v[96:111], v[184:187], v[180:183], v[96:111]
    v_mfma_f32_32x32x16_bf16 v[112:127], v[188:191], v[180:183], v[112:127]
    ds_read_b128 v[168:171], v130 offset:0
    ds_read_b64_tr_b16 v[172:173], v132 offset:6144
    ds_read_b64_tr_b16 v[174:175], v132 offset:6400
    ds_read_b64_tr_b16 v[176:177], v132 offset:7168
    ds_read_b64_tr_b16 v[178:179], v132 offset:7424
    s_waitcnt lgkmcnt(10)
    v_mfma_f32_32x32x16_bf16 v[96:111], v[148:151], v[144:147], v[96:111]
    v_mfma_f32_32x32x16_bf16 v[112:127], v[152:155], v[144:147], v[112:127]
    ds_read_b128 v[180:183], v131 offset:0
    ds_read_b64_tr_b16 v[184:185], v132 offset:9216
    ds_read_b64_tr_b16 v[186:187], v132 offset:9472
    ds_read_b64_tr_b16 v[188:189], v132 offset:10240
    ds_read_b64_tr_b16 v[190:191], v132 offset:10496
    s_waitcnt lgkmcnt(10)
    v_mfma_f32_32x32x16_bf16 v[96:111], v[160:163], v[156:159], v[96:111]
    v_mfma_f32_32x32x16_bf16 v[112:127], v[164:167], v[156:159], v[112:127]
    s_barrier
    ds_read_b128 v[144:147], v128 offset:28672
    ds_read_b64_tr_b16 v[148:149], v132 offset:28672
    ds_read_b64_tr_b16 v[150:151], v132 offset:28928
    ds_read_b64_tr_b16 v[152:153], v132 offset:29696
    ds_read_b64_tr_b16 v[154:155], v132 offset:29952
    s_waitcnt lgkmcnt(10)
    v_mfma_f32_32x32x16_bf16 v[96:111], v[172:175], v[168:171], v[96:111]
    v_mfma_f32_32x32x16_bf16 v[112:127], v[176:179], v[168:171], v[112:127]
    ds_read_b128 v[156:159], v129 offset:28672
    ds_read_b64_tr_b16 v[160:161], v132 offset:31744
    ds_read_b64_tr_b16 v[162:163], v132 offset:32000
    ds_read_b64_tr_b16 v[164:165], v132 offset:32768
    ds_read_b64_tr_b16 v[166:167], v132 offset:33024
    s_waitcnt lgkmcnt(10)
    v_mfma_f32_32x32x16_bf16 v[96:111], v[184:187], v[180:183], v[96:111]
    v_mfma_f32_32x32x16_bf16 v[112:127], v[188:191], v[180:183], v[112:127]
    ds_read_b128 v[168:171], v130 offset:28672
    ds_read_b64_tr_b16 v[172:173], v132 offset:34816
    ds_read_b64_tr_b16 v[174:175], v132 offset:35072
    ds_read_b64_tr_b16 v[176:177], v132 offset:35840
    ds_read_b64_tr_b16 v[178:179], v132 offset:36096
    s_waitcnt lgkmcnt(10)
    v_mfma_f32_32x32x16_bf16 v[96:111], v[148:151], v[144:147], v[96:111]
    v_mfma_f32_32x32x16_bf16 v[112:127], v[152:155], v[144:147], v[112:127]
    ds_read_b128 v[180:183], v131 offset:28672
    ds_read_b64_tr_b16 v[184:185], v132 offset:37888
    ds_read_b64_tr_b16 v[186:187], v132 offset:38144
    ds_read_b64_tr_b16 v[188:189], v132 offset:38912
    ds_read_b64_tr_b16 v[190:191], v132 offset:39168
    s_waitcnt lgkmcnt(10)
    v_mfma_f32_32x32x16_bf16 v[96:111], v[160:163], v[156:159], v[96:111]
    v_mfma_f32_32x32x16_bf16 v[112:127], v[164:167], v[156:159], v[112:127]
    s_barrier
    ds_read_b128 v[144:147], v133 offset:0
    ds_read_b64_tr_b16 v[148:149], v137 offset:0
    ds_read_b64_tr_b16 v[150:151], v137 offset:256
    ds_read_b64_tr_b16 v[152:153], v137 offset:1024
    ds_read_b64_tr_b16 v[154:155], v137 offset:1280
    s_waitcnt lgkmcnt(10)
    v_mfma_f32_32x32x16_bf16 v[96:111], v[172:175], v[168:171], v[96:111]
    v_mfma_f32_32x32x16_bf16 v[112:127], v[176:179], v[168:171], v[112:127]
    ds_read_b128 v[156:159], v134 offset:0
    ds_read_b64_tr_b16 v[160:161], v137 offset:3072
    ds_read_b64_tr_b16 v[162:163], v137 offset:3328
    ds_read_b64_tr_b16 v[164:165], v137 offset:4096
    ds_read_b64_tr_b16 v[166:167], v137 offset:4352
    s_waitcnt lgkmcnt(10)
    v_mfma_f32_32x32x16_bf16 v[96:111], v[184:187], v[180:183], v[96:111]
    v_mfma_f32_32x32x16_bf16 v[112:127], v[188:191], v[180:183], v[112:127]
    ds_read_b128 v[168:171], v135 offset:0
    ds_read_b64_tr_b16 v[172:173], v137 offset:6144
    ds_read_b64_tr_b16 v[174:175], v137 offset:6400
    ds_read_b64_tr_b16 v[176:177], v137 offset:7168
    ds_read_b64_tr_b16 v[178:179], v137 offset:7424
    s_waitcnt lgkmcnt(10)
    v_mfma_f32_32x32x16_bf16 v[96:111], v[148:151], v[144:147], v[96:111]
    v_mfma_f32_32x32x16_bf16 v[112:127], v[152:155], v[144:147], v[112:127]
    ds_read_b128 v[180:183], v136 offset:0
    ds_read_b64_tr_b16 v[184:185], v137 offset:9216
    ds_read_b64_tr_b16 v[186:187], v137 offset:9472
    ds_read_b64_tr_b16 v[188:189], v137 offset:10240
    ds_read_b64_tr_b16 v[190:191], v137 offset:10496
    s_waitcnt lgkmcnt(10)
    v_mfma_f32_32x32x16_bf16 v[96:111], v[160:163], v[156:159], v[96:111]
    v_mfma_f32_32x32x16_bf16 v[112:127], v[164:167], v[156:159], v[112:127]
    s_barrier
    ds_read_b128 v[144:147], v133 offset:28672
    ds_read_b64_tr_b16 v[148:149], v137 offset:28672
    ds_read_b64_tr_b16 v[150:151], v137 offset:28928
    ds_read_b64_tr_b16 v[152:153], v137 offset:29696
    ds_read_b64_tr_b16 v[154:155], v137 offset:29952
    s_waitcnt lgkmcnt(10)
    v_mfma_f32_32x32x16_bf16 v[96:111], v[172:175], v[168:171], v[96:111]
    v_mfma_f32_32x32x16_bf16 v[112:127], v[176:179], v[168:171], v[112:127]
    ds_read_b128 v[156:159], v134 offset:28672
    ds_read_b64_tr_b16 v[160:161], v137 offset:31744
    ds_read_b64_tr_b16 v[162:163], v137 offset:32000
    ds_read_b64_tr_b16 v[164:165], v137 offset:32768
    ds_read_b64_tr_b16 v[166:167], v137 offset:33024
    s_waitcnt lgkmcnt(10)
    v_mfma_f32_32x32x16_bf16 v[96:111], v[184:187], v[180:183], v[96:111]
    v_mfma_f32_32x32x16_bf16 v[112:127], v[188:191], v[180:183], v[112:127]
    ds_read_b128 v[168:171], v135 offset:28672
    ds_read_b64_tr_b16 v[172:173], v137 offset:34816
    ds_read_b64_tr_b16 v[174:175], v137 offset:35072
    ds_read_b64_tr_b16 v[176:177], v137 offset:35840
    ds_read_b64_tr_b16 v[178:179], v137 offset:36096
    s_waitcnt lgkmcnt(10)
    v_mfma_f32_32x32x16_bf16 v[96:111], v[148:151], v[144:147], v[96:111]
    v_mfma_f32_32x32x16_bf16 v[112:127], v[152:155], v[144:147], v[112:127]
    ds_read_b128 v[180:183], v136 offset:28672
    ds_read_b64_tr_b16 v[184:185], v137 offset:37888
    ds_read_b64_tr_b16 v[186:187], v137 offset:38144
    ds_read_b64_tr_b16 v[188:189], v137 offset:38912
    ds_read_b64_tr_b16 v[190:191], v137 offset:39168
    s_waitcnt lgkmcnt(10)
    v_mfma_f32_32x32x16_bf16 v[96:111], v[160:163], v[156:159], v[96:111]
    v_mfma_f32_32x32x16_bf16 v[112:127], v[164:167], v[156:159], v[112:127]
    buffer_load_dword v28, v29, s[68:71], s92 offen sc1
    s_waitcnt lgkmcnt(5)
    v_mfma_f32_32x32x16_bf16 v[96:111], v[172:175], v[168:171], v[96:111]
    v_mfma_f32_32x32x16_bf16 v[112:127], v[176:179], v[168:171], v[112:127]
    s_waitcnt lgkmcnt(0)
    v_mfma_f32_32x32x16_bf16 v[96:111], v[184:187], v[180:183], v[96:111]
    v_mfma_f32_32x32x16_bf16 v[112:127], v[188:191], v[180:183], v[112:127]
    v_and_b32 v36, 0x33, v1
    v_bfe_u32 v37, v1, 2, 1
    v_lshl_or_b32 v36, v37, 3, v36
    v_bfe_u32 v37, v1, 3, 1
    v_lshl_or_b32 v36, v37, 2, v36
    v_lshlrev_b32 v36, 4, v36
    s_lshl_b32 s10, s15, 11
    v_add_u32 v38, s10, v36
    s_mov_b32 s12, 1052289595
    s_mov_b32 s13, 1052289595
    s_lshl_b32 s10, s15, 10
    v_lshl_add_u32 v37, v1, 4, s10
    v_cvt_pk_bf16_f32 v16, v112, v113
    v_cvt_pk_bf16_f32 v17, v114, v115
    v_cvt_pk_bf16_f32 v18, v116, v117
    v_cvt_pk_bf16_f32 v19, v118, v119
    v_cvt_pk_bf16_f32 v20, v120, v121
    v_cvt_pk_bf16_f32 v21, v122, v123
    v_cvt_pk_bf16_f32 v22, v124, v125
    v_cvt_pk_bf16_f32 v23, v126, v127
    ds_write_b128 v38, v[16:19] offset:28672
    ds_write_b128 v38, v[20:23] offset:36864
    v_pk_mul_f32 v[96:97], v[96:97], s[12:13]
    v_pk_mul_f32 v[98:99], v[98:99], s[12:13]
    v_pk_mul_f32 v[100:101], v[100:101], s[12:13]
    v_pk_mul_f32 v[102:103], v[102:103], s[12:13]
    v_pk_mul_f32 v[104:105], v[104:105], s[12:13]
    v_pk_mul_f32 v[106:107], v[106:107], s[12:13]
    v_pk_mul_f32 v[108:109], v[108:109], s[12:13]
    v_pk_mul_f32 v[110:111], v[110:111], s[12:13]
    v_cvt_pk_bf16_f32 v8, v96, v97
    v_cvt_pk_bf16_f32 v9, v98, v99
    v_cvt_pk_bf16_f32 v10, v100, v101
    v_cvt_pk_bf16_f32 v11, v102, v103
    v_cvt_pk_bf16_f32 v12, v104, v105
    v_cvt_pk_bf16_f32 v13, v106, v107
    v_cvt_pk_bf16_f32 v14, v108, v109
    v_cvt_pk_bf16_f32 v15, v110, v111
    v_add_u32 v37, 147968, v37
    ds_write_b128 v37, v[8:11]
    ds_write_b128 v37, v[12:15] offset:4096
    v_dot2_f32_bf16 v42, v8, v8, 0
    v_dot2_f32_bf16 v43, v12, v12, 0
    v_dot2_f32_bf16 v41, v16, v16, 0
    v_dot2_f32_bf16 v44, v20, v20, 0
    v_dot2_f32_bf16 v42, v9, v9, v42
    v_dot2_f32_bf16 v43, v13, v13, v43
    v_dot2_f32_bf16 v41, v17, v17, v41
    v_dot2_f32_bf16 v44, v21, v21, v44
    v_dot2_f32_bf16 v42, v10, v10, v42
    v_dot2_f32_bf16 v43, v14, v14, v43
    v_dot2_f32_bf16 v41, v18, v18, v41
    v_dot2_f32_bf16 v44, v22, v22, v44
    v_dot2_f32_bf16 v42, v11, v11, v42
    v_dot2_f32_bf16 v43, v15, v15, v43
    v_dot2_f32_bf16 v41, v19, v19, v41
    v_dot2_f32_bf16 v44, v23, v23, v44
    s_nop 0
    v_max_f32 v42, v42, v43
    s_nop 0
    v_max_f32 v41, v41, v44
    v_max_f32_dpp v42, v42, v42 row_shr:1 row_mask:0xf bank_mask:0xf
    s_nop 0
    v_max_f32_dpp v41, v41, v41 row_shr:1 row_mask:0xf bank_mask:0xf
    v_max_f32_dpp v42, v42, v42 row_shr:2 row_mask:0xf bank_mask:0xf
    s_nop 0
    v_max_f32_dpp v41, v41, v41 row_shr:2 row_mask:0xf bank_mask:0xf
    v_max_f32_dpp v42, v42, v42 row_shr:4 row_mask:0xf bank_mask:0xf
    s_nop 0
    v_max_f32_dpp v41, v41, v41 row_shr:4 row_mask:0xf bank_mask:0xf
    v_max_f32_dpp v42, v42, v42 row_shr:8 row_mask:0xf bank_mask:0xf
    s_nop 0
    v_max_f32_dpp v41, v41, v41 row_shr:8 row_mask:0xf bank_mask:0xf
    v_max_f32_dpp v42, v42, v42 row_bcast:15 row_mask:0xa bank_mask:0xf
    s_nop 0
    v_max_f32_dpp v41, v41, v41 row_bcast:15 row_mask:0xa bank_mask:0xf
    v_max_f32_dpp v42, v42, v42 row_bcast:31 row_mask:0xc bank_mask:0xf
    s_nop 0
    v_max_f32_dpp v41, v41, v41 row_bcast:31 row_mask:0xc bank_mask:0xf
    s_lshl_b32 s10, s15, 2
    s_add_u32 s10, s10, 156160
    v_mov_b32 v37, s10
    s_lshl_b64 exec, 1, 63
    ds_write_b32 v37, v42
    ds_write_b32 v37, v41 offset:32
    s_mov_b64 exec, -1
    s_waitcnt lgkmcnt(0)
    s_barrier
    ds_read_b128 v[208:211], v68 offset:28672
    ds_read_b128 v[192:195], v64
    ds_read_b128 v[196:199], v65
    ds_read_b128 v[200:203], v66
    ds_read_b128 v[204:207], v67
    s_mov_b32 exec_lo, 0xffff
    s_mov_b32 exec_hi, 0xffff
    ds_read_b128 v[212:215], v69 offset:29696
    ds_read_b128 v[216:219], v69 offset:30208
    s_mov_b64 exec, -1
    ds_read_b32 v42, v70
    ds_read_b32 v41, v70 offset:32
    s_mov_b32 s82, 262144
    s_waitcnt vmcnt(0)
    s_branch L_pollu_chk
L_pollu:
    buffer_load_dword v28, v29, s[68:71], s92 offen sc1
    s_waitcnt vmcnt(0)
L_pollu_chk:
    v_cmp_ne_u32 vcc, s43, v28
    s_cbranch_vccz L_pollu_ok
    s_sub_u32 s82, s82, 1
    s_cbranch_scc0 L_pollu
L_pollu_ok:
    s_mul_i32 s92, s15, 4576
    s_add_u32 m0, s92, 0
    s_nop 0
    buffer_load_dwordx4 v245, s[68:71], s94 offen offset:0 sc1 lds
    buffer_load_dwordx4 v245, s[68:71], s94 offen offset:1024 sc1 lds
    buffer_load_dwordx4 v245, s[68:71], s94 offen offset:2048 sc1 lds
    buffer_load_dwordx4 v245, s[68:71], s94 offen offset:3072 sc1 lds
    s_mov_b32 s64, s34
    s_mov_b32 s65, s35
    s_mov_b32 s66, 1024
    s_mov_b32 s67, 0x20000
    s_lshl_b32 s14, s5, 2
    s_add_u32 s14, s14, s15
    s_lshl_b32 s14, s14, 4
    s_add_u32 s14, s14, s4
    s_lshl_b32 s10, s14, 11
    buffer_load_dwordx4 v[48:51], v245, s[44:47], s10 offen
    buffer_load_dwordx4 v[52:55], v245, s[44:47], s10 offen offset:1024
    buffer_load_dwordx4 v[56:59], v245, s[64:67], 0 offen
    v_mov_b32 v32, 0
    v_mov_b32 v33, 0
    v_mov_b32 v34, 0
    v_mov_b32 v35, 0
    s_nop 1
    v_mfma_f32_32x32x16_bf16 v[64:79], v[32:35], v[32:35], 0
    v_mfma_f32_32x32x16_bf16 v[80:95], v[32:35], v[32:35], 0
    v_mfma_f32_32x32x16_bf16 v[96:111], v[32:35], v[32:35], 0
    v_mfma_f32_32x32x16_bf16 v[112:127], v[32:35], v[32:35], 0
    s_waitcnt lgkmcnt(0)
    v_mfma_f32_32x32x16_bf16 v[128:143], v[208:211], v[192:195], 0
    v_mfma_f32_32x32x16_bf16 v[144:159], v[208:211], v[196:199], 0
    s_nop 10
    v_exp_f32 v128, v128
    v_exp_f32 v129, v129
    v_exp_f32 v130, v130
    v_exp_f32 v131, v131
    v_exp_f32 v132, v132
    v_exp_f32 v133, v133
    v_exp_f32 v134, v134
    v_exp_f32 v135, v135
    v_exp_f32 v136, v136
    v_exp_f32 v137, v137
    v_smfmac_f32_32x32x32_bf16 v[64:79], v[212:215], v[128:135], v244
    v_exp_f32 v138, v138
    v_exp_f32 v139, v139
    v_exp_f32 v140, v140
    v_exp_f32 v141, v141
    v_exp_f32 v142, v142
    v_exp_f32 v143, v143
    v_mfma_f32_32x32x16_bf16 v[160:175], v[208:211], v[200:203], 0
    v_exp_f32 v144, v144
    v_exp_f32 v145, v145
    v_exp_f32 v146, v146
    v_exp_f32 v147, v147
    v_smfmac_f32_32x32x32_bf16 v[64:79], v[216:219], v[136:143], v244
    v_exp_f32 v148, v148
    v_exp_f32 v149, v149
    v_exp_f32 v150, v150
    v_exp_f32 v151, v151
    v_exp_f32 v152, v152
    v_exp_f32 v153, v153
    v_smfmac_f32_32x32x32_bf16 v[80:95], v[212:215], v[144:151], v244
    v_exp_f32 v154, v154
    v_exp_f32 v155, v155
    v_exp_f32 v156, v156
    v_exp_f32 v157, v157
    v_exp_f32 v158, v158
    v_exp_f32 v159, v159
    v_mfma_f32_32x32x16_bf16 v[176:191], v[208:211], v[204:207], 0
    v_exp_f32 v160, v160
    v_exp_f32 v161, v161
    v_exp_f32 v162, v162
    v_exp_f32 v163, v163
    v_smfmac_f32_32x32x32_bf16 v[80:95], v[216:219], v[152:159], v244
    v_exp_f32 v164, v164
    v_exp_f32 v165, v165
    v_exp_f32 v166, v166
    v_exp_f32 v167, v167
    v_exp_f32 v168, v168
    v_exp_f32 v169, v169
    v_smfmac_f32_32x32x32_bf16 v[96:111], v[212:215], v[160:167], v244
    v_exp_f32 v170, v170
    v_exp_f32 v171, v171
    v_exp_f32 v172, v172
    v_exp_f32 v173, v173
    v_exp_f32 v174, v174
    v_exp_f32 v175, v175
    v_exp_f32 v176, v176
    v_exp_f32 v177, v177
    v_exp_f32 v178, v178
    v_exp_f32 v179, v179
    v_smfmac_f32_32x32x32_bf16 v[96:111], v[216:219], v[168:175], v244
    v_exp_f32 v180, v180
    v_exp_f32 v181, v181
    v_exp_f32 v182, v182
    v_exp_f32 v183, v183
    v_exp_f32 v184, v184
    v_exp_f32 v185, v185
    v_smfmac_f32_32x32x32_bf16 v[112:127], v[212:215], v[176:183], v244
    v_exp_f32 v186, v186
    v_exp_f32 v187, v187
    v_exp_f32 v188, v188
    v_exp_f32 v189, v189
    v_exp_f32 v190, v190
    v_exp_f32 v191, v191
    s_waitcnt vmcnt(3)
    v_lshl_add_u32 v12, v1, 3, s92
    v_mov_b32 v10, 0
    v_mov_b32 v11, 0
    s_lshr_b64 exec, -1, 4
    ds_write_b64 v12, v[10:11] offset:4096
    s_and_b32 s8, s3, 1
    s_xor_b32 exec_lo, s8, 1
    s_mov_b32 exec_hi, 0
    ds_write_b16 v12, v10 offset:4094
    s_mov_b64 exec, -1
    s_waitcnt vmcnt(0)
    v_dot2_f32_bf16 v10, v48, v56, 0
    v_dot2_f32_bf16 v11, v52, v56, 0
    v_dot2_f32_bf16 v10, v49, v57, v10
    v_dot2_f32_bf16 v11, v53, v57, v11
    v_dot2_f32_bf16 v10, v50, v58, v10
    v_dot2_f32_bf16 v11, v54, v58, v11
    v_dot2_f32_bf16 v10, v51, v59, v10
    v_dot2_f32_bf16 v11, v55, v59, v11
    s_nop 1
    v_add_f32_dpp v10, v10, v10 row_shr:1 row_mask:0xf bank_mask:0xf
    v_add_f32_dpp v11, v11, v11 row_shr:1 row_mask:0xf bank_mask:0xf
    s_nop 0
    v_add_f32_dpp v10, v10, v10 row_shr:2 row_mask:0xf bank_mask:0xf
    v_add_f32_dpp v11, v11, v11 row_shr:2 row_mask:0xf bank_mask:0xf
    s_nop 0
    v_add_f32_dpp v10, v10, v10 row_shr:4 row_mask:0xf bank_mask:0xf
    v_add_f32_dpp v11, v11, v11 row_shr:4 row_mask:0xf bank_mask:0xf
    s_nop 0
    v_add_f32_dpp v10, v10, v10 row_shr:8 row_mask:0xf bank_mask:0xf
    v_add_f32_dpp v11, v11, v11 row_shr:8 row_mask:0xf bank_mask:0xf
    s_nop 0
    v_add_f32_dpp v10, v10, v10 row_bcast:15 row_mask:0xa bank_mask:0xf
    v_add_f32_dpp v11, v11, v11 row_bcast:15 row_mask:0xa bank_mask:0xf
    s_nop 0
    v_add_f32_dpp v10, v10, v10 row_bcast:31 row_mask:0xc bank_mask:0xf
    v_add_f32_dpp v11, v11, v11 row_bcast:31 row_mask:0xc bank_mask:0xf
    v_mul_f32 v10, 3216550459, v10
    v_mul_f32 v11, 3216550459, v11
    v_exp_f32 v10, v10
    v_exp_f32 v11, v11
    v_add_f32 v10, 1.0, v10
    v_add_f32 v11, 1.0, v11
    v_rcp_f32 v10, v10
    v_rcp_f32 v11, v11
    s_lshl_b32 s10, s14, 3
    s_add_u32 s10, s10, 14680064
    v_mov_b32 v2, 0
    s_lshl_b64 exec, 1, 63
    buffer_store_dwordx2 v[10:11], v2, s[68:71], s10 offen sc1
    s_mov_b64 exec, -1
    s_waitcnt lgkmcnt(0)
    s_barrier
    ds_read_b128 v[172:175], v249 offset:0
    ds_read_b128 v[48:51], v248 offset:0
    ds_read_b128 v[168:171], v249 offset:512
    ds_read_b128 v[52:55], v248 offset:512
    ds_read_b128 v[164:167], v249 offset:1024
    ds_read_b128 v[56:59], v248 offset:1024
    ds_read_b128 v[160:163], v249 offset:1536
    ds_read_b128 v[60:63], v248 offset:1536
    ds_read_b128 v[156:159], v249 offset:2048
    ds_read_b128 v[128:131], v248 offset:2048
    ds_read_b128 v[152:155], v249 offset:2560
    ds_read_b128 v[132:135], v248 offset:2560
    ds_read_b128 v[148:151], v249 offset:3072
    ds_read_b128 v[136:139], v248 offset:3072
    ds_read_b128 v[144:147], v249 offset:3584
    ds_read_b128 v[140:143], v248 offset:3584
    s_lshl_b32 s9, s3, 13
    s_add_u32 s9, s9, 57344
    v_add_u32 v2, s9, v245
    s_mov_b32 s8, 1
    v_add_u32 v248, 64, v248
    v_add_u32 v249, 64, v249
    s_waitcnt lgkmcnt(14)
    v_mfma_f32_16x16x32_bf16 v[44:47], v[48:51], v[172:175], 0
    ds_read_b128 v[172:175], v249 offset:0
    s_waitcnt lgkmcnt(14)
    v_mfma_f32_16x16x32_bf16 v[40:43], v[48:51], v[168:171], 0
    s_waitcnt lgkmcnt(12)
    v_mfma_f32_16x16x32_bf16 v[36:39], v[48:51], v[164:167], 0
    s_waitcnt lgkmcnt(10)
    v_mfma_f32_16x16x32_bf16 v[32:35], v[48:51], v[160:163], 0
    s_waitcnt lgkmcnt(8)
    v_mfma_f32_16x16x32_bf16 v[28:31], v[48:51], v[156:159], 0
    s_waitcnt lgkmcnt(6)
    v_mfma_f32_16x16x32_bf16 v[24:27], v[48:51], v[152:155], 0
    s_waitcnt lgkmcnt(4)
    v_mfma_f32_16x16x32_bf16 v[20:23], v[48:51], v[148:151], 0
    s_waitcnt lgkmcnt(2)
    v_mfma_f32_16x16x32_bf16 v[16:19], v[48:51], v[144:147], 0
    ds_read_b128 v[48:51], v248 offset:0
    v_mfma_f32_16x16x32_bf16 v[44:47], v[52:55], v[168:171], v[44:47]
    ds_read_b128 v[168:171], v249 offset:512
    v_mfma_f32_16x16x32_bf16 v[40:43], v[52:55], v[164:167], v[40:43]
    v_mfma_f32_16x16x32_bf16 v[36:39], v[52:55], v[160:163], v[36:39]
    v_mfma_f32_16x16x32_bf16 v[32:35], v[52:55], v[156:159], v[32:35]
    v_mfma_f32_16x16x32_bf16 v[28:31], v[52:55], v[152:155], v[28:31]
    v_mfma_f32_16x16x32_bf16 v[24:27], v[52:55], v[148:151], v[24:27]
    v_mfma_f32_16x16x32_bf16 v[20:23], v[52:55], v[144:147], v[20:23]
    ds_read_b128 v[52:55], v248 offset:512
    v_mfma_f32_16x16x32_bf16 v[44:47], v[56:59], v[164:167], v[44:47]
    ds_read_b128 v[164:167], v249 offset:1024
    v_mfma_f32_16x16x32_bf16 v[40:43], v[56:59], v[160:163], v[40:43]
    v_mfma_f32_16x16x32_bf16 v[36:39], v[56:59], v[156:159], v[36:39]
    v_mfma_f32_16x16x32_bf16 v[32:35], v[56:59], v[152:155], v[32:35]
    v_mfma_f32_16x16x32_bf16 v[28:31], v[56:59], v[148:151], v[28:31]
    v_mfma_f32_16x16x32_bf16 v[24:27], v[56:59], v[144:147], v[24:27]
    ds_read_b128 v[56:59], v248 offset:1024
    v_mfma_f32_16x16x32_bf16 v[44:47], v[60:63], v[160:163], v[44:47]
    ds_read_b128 v[160:163], v249 offset:1536
    v_mfma_f32_16x16x32_bf16 v[40:43], v[60:63], v[156:159], v[40:43]
    v_mfma_f32_16x16x32_bf16 v[36:39], v[60:63], v[152:155], v[36:39]
    v_mfma_f32_16x16x32_bf16 v[32:35], v[60:63], v[148:151], v[32:35]
    v_mfma_f32_16x16x32_bf16 v[28:31], v[60:63], v[144:147], v[28:31]
    ds_read_b128 v[60:63], v248 offset:1536
    v_mfma_f32_16x16x32_bf16 v[44:47], v[128:131], v[156:159], v[44:47]
    ds_read_b128 v[156:159], v249 offset:2048
    v_mfma_f32_16x16x32_bf16 v[40:43], v[128:131], v[152:155], v[40:43]
    v_mfma_f32_16x16x32_bf16 v[36:39], v[128:131], v[148:151], v[36:39]
    v_mfma_f32_16x16x32_bf16 v[32:35], v[128:131], v[144:147], v[32:35]
    ds_read_b128 v[128:131], v248 offset:2048
    v_mfma_f32_16x16x32_bf16 v[44:47], v[132:135], v[152:155], v[44:47]
    ds_read_b128 v[152:155], v249 offset:2560
    v_mfma_f32_16x16x32_bf16 v[40:43], v[132:135], v[148:151], v[40:43]
    v_mfma_f32_16x16x32_bf16 v[36:39], v[132:135], v[144:147], v[36:39]
    ds_read_b128 v[132:135], v248 offset:2560
    v_mfma_f32_16x16x32_bf16 v[44:47], v[136:139], v[148:151], v[44:47]
    ds_read_b128 v[148:151], v249 offset:3072
    v_mfma_f32_16x16x32_bf16 v[40:43], v[136:139], v[144:147], v[40:43]
    ds_read_b128 v[136:139], v248 offset:3072
    s_waitcnt lgkmcnt(14)
    v_mfma_f32_16x16x32_bf16 v[44:47], v[140:143], v[144:147], v[44:47]
    ds_read_b128 v[144:147], v249 offset:3584
    ds_read_b128 v[140:143], v248 offset:3584
L_cvloop:
    v_add_u32 v248, 64, v248
    v_add_u32 v249, 64, v249
    s_waitcnt lgkmcnt(14)
    v_mfma_f32_16x16x32_bf16 v[44:47], v[48:51], v[172:175], v[44:47]
    ds_read_b128 v[172:175], v249 offset:0
    s_waitcnt lgkmcnt(14)
    v_mfma_f32_16x16x32_bf16 v[40:43], v[48:51], v[168:171], v[40:43]
    s_waitcnt lgkmcnt(12)
    v_mfma_f32_16x16x32_bf16 v[36:39], v[48:51], v[164:167], v[36:39]
    s_waitcnt lgkmcnt(10)
    v_mfma_f32_16x16x32_bf16 v[32:35], v[48:51], v[160:163], v[32:35]
    s_waitcnt lgkmcnt(8)
    v_mfma_f32_16x16x32_bf16 v[28:31], v[48:51], v[156:159], v[28:31]
    s_waitcnt lgkmcnt(6)
    v_mfma_f32_16x16x32_bf16 v[24:27], v[48:51], v[152:155], v[24:27]
    s_waitcnt lgkmcnt(4)
    v_mfma_f32_16x16x32_bf16 v[20:23], v[48:51], v[148:151], v[20:23]
    s_waitcnt lgkmcnt(2)
    v_mfma_f32_16x16x32_bf16 v[16:19], v[48:51], v[144:147], v[16:19]
    ds_read_b128 v[48:51], v248 offset:0
    v_mfma_f32_16x16x32_bf16 v[44:47], v[52:55], v[168:171], v[44:47]
    ds_read_b128 v[168:171], v249 offset:512
    v_mfma_f32_16x16x32_bf16 v[40:43], v[52:55], v[164:167], v[40:43]
    v_mfma_f32_16x16x32_bf16 v[36:39], v[52:55], v[160:163], v[36:39]
    v_mfma_f32_16x16x32_bf16 v[32:35], v[52:55], v[156:159], v[32:35]
    v_mfma_f32_16x16x32_bf16 v[28:31], v[52:55], v[152:155], v[28:31]
    v_mfma_f32_16x16x32_bf16 v[24:27], v[52:55], v[148:151], v[24:27]
    v_mfma_f32_16x16x32_bf16 v[20:23], v[52:55], v[144:147], v[20:23]
    ds_read_b128 v[52:55], v248 offset:512
    v_mfma_f32_16x16x32_bf16 v[44:47], v[56:59], v[164:167], v[44:47]
    ds_read_b128 v[164:167], v249 offset:1024
    v_mfma_f32_16x16x32_bf16 v[40:43], v[56:59], v[160:163], v[40:43]
    v_mfma_f32_16x16x32_bf16 v[36:39], v[56:59], v[156:159], v[36:39]
    v_mfma_f32_16x16x32_bf16 v[32:35], v[56:59], v[152:155], v[32:35]
    v_mfma_f32_16x16x32_bf16 v[28:31], v[56:59], v[148:151], v[28:31]
    v_mfma_f32_16x16x32_bf16 v[24:27], v[56:59], v[144:147], v[24:27]
    ds_read_b128 v[56:59], v248 offset:1024
    v_mfma_f32_16x16x32_bf16 v[44:47], v[60:63], v[160:163], v[44:47]
    ds_read_b128 v[160:163], v249 offset:1536
    v_mfma_f32_16x16x32_bf16 v[40:43], v[60:63], v[156:159], v[40:43]
    v_mfma_f32_16x16x32_bf16 v[36:39], v[60:63], v[152:155], v[36:39]
    v_mfma_f32_16x16x32_bf16 v[32:35], v[60:63], v[148:151], v[32:35]
    v_mfma_f32_16x16x32_bf16 v[28:31], v[60:63], v[144:147], v[28:31]
    ds_read_b128 v[60:63], v248 offset:1536
    v_mfma_f32_16x16x32_bf16 v[44:47], v[128:131], v[156:159], v[44:47]
    ds_read_b128 v[156:159], v249 offset:2048
    v_mfma_f32_16x16x32_bf16 v[40:43], v[128:131], v[152:155], v[40:43]
    v_mfma_f32_16x16x32_bf16 v[36:39], v[128:131], v[148:151], v[36:39]
    v_mfma_f32_16x16x32_bf16 v[32:35], v[128:131], v[144:147], v[32:35]
    ds_read_b128 v[128:131], v248 offset:2048
    v_mfma_f32_16x16x32_bf16 v[44:47], v[132:135], v[152:155], v[44:47]
    ds_read_b128 v[152:155], v249 offset:2560
    v_mfma_f32_16x16x32_bf16 v[40:43], v[132:135], v[148:151], v[40:43]
    v_mfma_f32_16x16x32_bf16 v[36:39], v[132:135], v[144:147], v[36:39]
    ds_read_b128 v[132:135], v248 offset:2560
    v_mfma_f32_16x16x32_bf16 v[44:47], v[136:139], v[148:151], v[44:47]
    ds_read_b128 v[148:151], v249 offset:3072
    v_mfma_f32_16x16x32_bf16 v[40:43], v[136:139], v[144:147], v[40:43]
    ds_read_b128 v[136:139], v248 offset:3072
    s_waitcnt lgkmcnt(14)
    v_mfma_f32_16x16x32_bf16 v[44:47], v[140:143], v[144:147], v[44:47]
    ds_read_b128 v[144:147], v249 offset:3584
    ds_read_b128 v[140:143], v248 offset:3584
    s_sub_u32 s8, s8, 1
    s_cbranch_scc0 L_cvloop
    s_waitcnt lgkmcnt(14)
    v_mfma_f32_16x16x32_bf16 v[44:47], v[48:51], v[172:175], v[44:47]
    s_waitcnt lgkmcnt(13)
    v_mfma_f32_16x16x32_bf16 v[40:43], v[48:51], v[168:171], v[40:43]
    s_waitcnt lgkmcnt(11)
    v_mfma_f32_16x16x32_bf16 v[36:39], v[48:51], v[164:167], v[36:39]
    s_waitcnt lgkmcnt(9)
    v_mfma_f32_16x16x32_bf16 v[32:35], v[48:51], v[160:163], v[32:35]
    s_waitcnt lgkmcnt(7)
    v_mfma_f32_16x16x32_bf16 v[28:31], v[48:51], v[156:159], v[28:31]
    s_waitcnt lgkmcnt(5)
    v_mfma_f32_16x16x32_bf16 v[24:27], v[48:51], v[152:155], v[24:27]
    s_waitcnt lgkmcnt(3)
    v_mfma_f32_16x16x32_bf16 v[20:23], v[48:51], v[148:151], v[20:23]
    s_waitcnt lgkmcnt(1)
    v_mfma_f32_16x16x32_bf16 v[16:19], v[48:51], v[144:147], v[16:19]
    v_mfma_f32_16x16x32_bf16 v[44:47], v[52:55], v[168:171], v[44:47]
    v_mfma_f32_16x16x32_bf16 v[40:43], v[52:55], v[164:167], v[40:43]
    v_mfma_f32_16x16x32_bf16 v[36:39], v[52:55], v[160:163], v[36:39]
    v_mfma_f32_16x16x32_bf16 v[32:35], v[52:55], v[156:159], v[32:35]
    v_mfma_f32_16x16x32_bf16 v[28:31], v[52:55], v[152:155], v[28:31]
    v_mfma_f32_16x16x32_bf16 v[24:27], v[52:55], v[148:151], v[24:27]
    v_mfma_f32_16x16x32_bf16 v[20:23], v[52:55], v[144:147], v[20:23]
    v_mfma_f32_16x16x32_bf16 v[44:47], v[56:59], v[164:167], v[44:47]
    ds_write_b128 v2, v[16:19] offset:0
    v_mfma_f32_16x16x32_bf16 v[40:43], v[56:59], v[160:163], v[40:43]
    v_mfma_f32_16x16x32_bf16 v[36:39], v[56:59], v[156:159], v[36:39]
    v_mfma_f32_16x16x32_bf16 v[32:35], v[56:59], v[152:155], v[32:35]
    v_mfma_f32_16x16x32_bf16 v[28:31], v[56:59], v[148:151], v[28:31]
    v_mfma_f32_16x16x32_bf16 v[24:27], v[56:59], v[144:147], v[24:27]
    v_mfma_f32_16x16x32_bf16 v[44:47], v[60:63], v[160:163], v[44:47]
    ds_write_b128 v2, v[20:23] offset:1024
    v_mfma_f32_16x16x32_bf16 v[40:43], v[60:63], v[156:159], v[40:43]
    v_mfma_f32_16x16x32_bf16 v[36:39], v[60:63], v[152:155], v[36:39]
    v_mfma_f32_16x16x32_bf16 v[32:35], v[60:63], v[148:151], v[32:35]
    v_mfma_f32_16x16x32_bf16 v[28:31], v[60:63], v[144:147], v[28:31]
    v_mfma_f32_16x16x32_bf16 v[44:47], v[128:131], v[156:159], v[44:47]
    v_mfma_f32_16x16x32_bf16 v[40:43], v[128:131], v[152:155], v[40:43]
    ds_write_b128 v2, v[24:27] offset:2048
    v_mfma_f32_16x16x32_bf16 v[36:39], v[128:131], v[148:151], v[36:39]
    v_mfma_f32_16x16x32_bf16 v[32:35], v[128:131], v[144:147], v[32:35]
    v_mfma_f32_16x16x32_bf16 v[44:47], v[132:135], v[152:155], v[44:47]
    v_mfma_f32_16x16x32_bf16 v[40:43], v[132:135], v[148:151], v[40:43]
    v_mfma_f32_16x16x32_bf16 v[36:39], v[132:135], v[144:147], v[36:39]
    ds_write_b128 v2, v[28:31] offset:3072
    v_mfma_f32_16x16x32_bf16 v[44:47], v[136:139], v[148:151], v[44:47]
    v_mfma_f32_16x16x32_bf16 v[40:43], v[136:139], v[144:147], v[40:43]
    s_waitcnt lgkmcnt(4)
    v_mfma_f32_16x16x32_bf16 v[44:47], v[140:143], v[144:147], v[44:47]
    ds_write_b128 v2, v[32:35] offset:4096
    s_nop 1
    ds_write_b128 v2, v[36:39] offset:5120
    s_nop 1
    ds_write_b128 v2, v[40:43] offset:6144
    s_nop 0
    ds_write_b128 v2, v[44:47] offset:7168
    s_waitcnt lgkmcnt(0)
    s_barrier
    s_add_u32 s89, s89, 32768
    s_xor_b32 s38, s88, s89
    global_load_dwordx4 v[220:223], v245, s[38:39] sc1
    global_load_dwordx4 v[224:227], v246, s[38:39] offset:1024 sc1
    global_load_dwordx4 v[228:231], v247, s[38:39] offset:1536 sc1
    s_add_u32 s89, s89, 32768
    s_xor_b32 s38, s88, s89
    global_load_dwordx4 v[232:235], v245, s[38:39] sc1
    global_load_dwordx4 v[236:239], v246, s[38:39] offset:1024 sc1
    global_load_dwordx4 v[240:243], v247, s[38:39] offset:1536 sc1
    s_branch L_join
L_vrole:
    v_lshrrev_b32 v36, 3, v1
    v_lshrrev_b32 v37, 4, v1
    v_xor_b32 v37, v37, v1
    v_and_b32 v37, 7, v37
    v_lshlrev_b32 v37, 4, v37
    v_lshl_add_u32 v37, v36, 10, v37
    s_lshl_b32 s8, s5, 2
    s_add_u32 s8, s8, s15
    s_lshl_b32 s8, s8, 15
    v_add_u32 v4, s8, v37
    v_xor_b32 v5, 64, v4
    v_add_u32 v6, 14336, v4
    v_add_u32 v7, 21504, v5
    v_add_u32 v5, 7168, v5
    s_lshl_b32 s12, s15, 12
    v_bfe_u32 v36, v0, 2, 6
    v_mul_u32_u24 v36, 0xc00, v36
    v_and_b32 v37, 3, v1
    v_lshl_add_u32 v36, v37, 4, v36
    s_lshl_b32 s8, s4, 6
    v_add_u32 v3, s8, v36
    s_mul_i32 s13, s15, 3072
    s_add_u32 s13, s13, 16384
    s_waitcnt lgkmcnt(0)
    s_mov_b32 s44, s16
    s_mov_b32 s45, s17
    s_mov_b32 s46, 2097152
    s_mov_b32 s47, 0x20000
    s_mov_b32 s48, s18
    s_mov_b32 s49, s19
    s_mov_b32 s50, 1572864
    s_mov_b32 s51, 0x20000
    s_add_u32 s9, s81, 0
    s_and_b32 s9, s9, 7
    s_add_u32 m0, s12, 0
    s_lshl_b32 s8, s9, 7
    buffer_load_dwordx4 v4, s[44:47], s8 offen offset:0 lds
    buffer_load_dwordx4 v5, s[44:47], s8 offen offset:1024 lds
    buffer_load_dwordx4 v6, s[44:47], s8 offen offset:2048 lds
    buffer_load_dwordx4 v7, s[44:47], s8 offen offset:3072 lds
    s_add_u32 m0, s13, 0
    s_mul_i32 s8, s9, 196608
    buffer_load_dwordx4 v3, s[48:51], s8 offen offset:0 lds
    buffer_load_dwordx4 v3, s[48:51], s8 offen offset:1024 lds
    buffer_load_dwordx4 v3, s[48:51], s8 offen offset:2048 lds
    s_add_u32 s9, s81, 1
    s_and_b32 s9, s9, 7
    s_add_u32 m0, s12, 28672
    s_lshl_b32 s8, s9, 7
    buffer_load_dwordx4 v4, s[44:47], s8 offen offset:0 lds
    buffer_load_dwordx4 v5, s[44:47], s8 offen offset:1024 lds
    buffer_load_dwordx4 v6, s[44:47], s8 offen offset:2048 lds
    buffer_load_dwordx4 v7, s[44:47], s8 offen offset:3072 lds
    s_add_u32 m0, s13, 28672
    s_mul_i32 s8, s9, 196608
    buffer_load_dwordx4 v3, s[48:51], s8 offen offset:0 lds
    buffer_load_dwordx4 v3, s[48:51], s8 offen offset:1024 lds
    buffer_load_dwordx4 v3, s[48:51], s8 offen offset:2048 lds
    s_add_u32 s40, s40, 0xfffff
    s_addc_u32 s41, s41, 0
    s_and_b32 s40, s40, 0xfff00000
    s_mov_b32 s68, s40
    s_mov_b32 s69, s41
    s_mov_b32 s70, 20971520
    s_mov_b32 s71, 0x20000
    buffer_load_dword v254, v2, s[68:71], 0 offen sc0 sc1
    v_and_b32 v56, 31, v1
    v_lshrrev_b32 v57, 5, v1
    v_bfe_u32 v58, v1, 1, 3
    v_xor_b32 v58, v58, v57
    v_lshlrev_b32 v58, 4, v58
    v_lshl_add_u32 v58, v56, 7, v58
    s_lshl_b32 s8, s15, 12
    v_add_u32 v128, s8, v58
    v_xor_b32 v129, 32, v128
    v_xor_b32 v130, 64, v128
    v_xor_b32 v131, 0x60, v128
    v_bfe_u32 v58, v1, 2, 2
    v_lshl_add_u32 v58, v57, 3, v58
    v_lshlrev_b32 v58, 6, v58
    v_bfe_u32 v59, v1, 4, 1
    v_lshl_add_u32 v58, v59, 5, v58
    v_and_b32 v59, 3, v1
    v_lshl_add_u32 v58, v59, 3, v58
    v_add_u32 v132, 0x4000, v58
    v_add_u32 v133, 57344, v128
    v_add_u32 v134, 57344, v129
    v_add_u32 v135, 57344, v130
    v_add_u32 v136, 57344, v131
    v_add_u32 v137, 57344, v132
    s_waitcnt vmcnt(8)
    s_barrier
    s_add_u32 s9, s81, 2
    s_and_b32 s9, s9, 7
    s_add_u32 m0, s12, 57344
    s_lshl_b32 s8, s9, 7
    buffer_load_dwordx4 v4, s[44:47], s8 offen offset:0 lds
    buffer_load_dwordx4 v5, s[44:47], s8 offen offset:1024 lds
    buffer_load_dwordx4 v6, s[44:47], s8 offen offset:2048 lds
    buffer_load_dwordx4 v7, s[44:47], s8 offen offset:3072 lds
    s_add_u32 m0, s13, 57344
    s_mul_i32 s8, s9, 196608
    buffer_load_dwordx4 v3, s[48:51], s8 offen offset:0 lds
    buffer_load_dwordx4 v3, s[48:51], s8 offen offset:1024 lds
    buffer_load_dwordx4 v3, s[48:51], s8 offen offset:2048 lds
    ds_read_b128 v[144:147], v128 offset:0
    ds_read_b64_tr_b16 v[148:149], v132 offset:2048
    ds_read_b64_tr_b16 v[150:151], v132 offset:2304
    ds_read_b128 v[152:155], v129 offset:0
    ds_read_b64_tr_b16 v[156:157], v132 offset:5120
    ds_read_b64_tr_b16 v[158:159], v132 offset:5376
    ds_read_b128 v[160:163], v130 offset:0
    ds_read_b64_tr_b16 v[164:165], v132 offset:8192
    ds_read_b64_tr_b16 v[166:167], v132 offset:8448
    ds_read_b128 v[168:171], v131 offset:0
    ds_read_b64_tr_b16 v[172:173], v132 offset:11264
    ds_read_b64_tr_b16 v[174:175], v132 offset:11520
    s_waitcnt lgkmcnt(9)
    v_mfma_f32_32x32x16_bf16 v[96:111], v[144:147], v[148:151], 0
    s_waitcnt lgkmcnt(6)
    v_mfma_f32_32x32x16_bf16 v[96:111], v[152:155], v[156:159], v[96:111]
    s_waitcnt lgkmcnt(3)
    v_mfma_f32_32x32x16_bf16 v[96:111], v[160:163], v[164:167], v[96:111]
    s_waitcnt lgkmcnt(0)
    v_mfma_f32_32x32x16_bf16 v[96:111], v[168:171], v[172:175], v[96:111]
    s_waitcnt vmcnt(8)
    s_barrier
    s_add_u32 s9, s81, 3
    s_and_b32 s9, s9, 7
    s_add_u32 m0, s12, 86016
    s_lshl_b32 s8, s9, 7
    buffer_load_dwordx4 v4, s[44:47], s8 offen offset:0 lds
    buffer_load_dwordx4 v5, s[44:47], s8 offen offset:1024 lds
    buffer_load_dwordx4 v6, s[44:47], s8 offen offset:2048 lds
    buffer_load_dwordx4 v7, s[44:47], s8 offen offset:3072 lds
    s_add_u32 m0, s13, 86016
    s_mul_i32 s8, s9, 196608
    buffer_load_dwordx4 v3, s[48:51], s8 offen offset:0 lds
    buffer_load_dwordx4 v3, s[48:51], s8 offen offset:1024 lds
    buffer_load_dwordx4 v3, s[48:51], s8 offen offset:2048 lds
    ds_read_b128 v[144:147], v128 offset:28672
    ds_read_b64_tr_b16 v[148:149], v132 offset:30720
    ds_read_b64_tr_b16 v[150:151], v132 offset:30976
    ds_read_b128 v[152:155], v129 offset:28672
    ds_read_b64_tr_b16 v[156:157], v132 offset:33792
    ds_read_b64_tr_b16 v[158:159], v132 offset:34048
    ds_read_b128 v[160:163], v130 offset:28672
    ds_read_b64_tr_b16 v[164:165], v132 offset:36864
    ds_read_b64_tr_b16 v[166:167], v132 offset:37120
    ds_read_b128 v[168:171], v131 offset:28672
    ds_read_b64_tr_b16 v[172:173], v132 offset:39936
    ds_read_b64_tr_b16 v[174:175], v132 offset:40192
    s_waitcnt lgkmcnt(9)
    v_mfma_f32_32x32x16_bf16 v[96:111], v[144:147], v[148:151], v[96:111]
    s_waitcnt lgkmcnt(6)
    v_mfma_f32_32x32x16_bf16 v[96:111], v[152:155], v[156:159], v[96:111]
    s_waitcnt lgkmcnt(3)
    v_mfma_f32_32x32x16_bf16 v[96:111], v[160:163], v[164:167], v[96:111]
    s_waitcnt lgkmcnt(0)
    v_mfma_f32_32x32x16_bf16 v[96:111], v[168:171], v[172:175], v[96:111]
    s_waitcnt vmcnt(7)
    s_barrier
    s_add_u32 s9, s81, 4
    s_and_b32 s9, s9, 7
    s_add_u32 m0, s12, 0
    s_lshl_b32 s8, s9, 7
    buffer_load_dwordx4 v4, s[44:47], s8 offen offset:0 lds
    buffer_load_dwordx4 v5, s[44:47], s8 offen offset:1024 lds
    buffer_load_dwordx4 v6, s[44:47], s8 offen offset:2048 lds
    buffer_load_dwordx4 v7, s[44:47], s8 offen offset:3072 lds
    s_add_u32 m0, s13, 0
    s_mul_i32 s8, s9, 196608
    buffer_load_dwordx4 v3, s[48:51], s8 offen offset:0 lds
    buffer_load_dwordx4 v3, s[48:51], s8 offen offset:1024 lds
    buffer_load_dwordx4 v3, s[48:51], s8 offen offset:2048 lds
    ds_read_b128 v[144:147], v133 offset:0
    ds_read_b64_tr_b16 v[148:149], v137 offset:2048
    ds_read_b64_tr_b16 v[150:151], v137 offset:2304
    ds_read_b128 v[152:155], v134 offset:0
    ds_read_b64_tr_b16 v[156:157], v137 offset:5120
    ds_read_b64_tr_b16 v[158:159], v137 offset:5376
    ds_read_b128 v[160:163], v135 offset:0
    ds_read_b64_tr_b16 v[164:165], v137 offset:8192
    ds_read_b64_tr_b16 v[166:167], v137 offset:8448
    ds_read_b128 v[168:171], v136 offset:0
    ds_read_b64_tr_b16 v[172:173], v137 offset:11264
    ds_read_b64_tr_b16 v[174:175], v137 offset:11520
    s_waitcnt lgkmcnt(9)
    v_mfma_f32_32x32x16_bf16 v[96:111], v[144:147], v[148:151], v[96:111]
    s_waitcnt lgkmcnt(6)
    v_mfma_f32_32x32x16_bf16 v[96:111], v[152:155], v[156:159], v[96:111]
    s_waitcnt lgkmcnt(3)
    v_mfma_f32_32x32x16_bf16 v[96:111], v[160:163], v[164:167], v[96:111]
    s_waitcnt lgkmcnt(0)
    v_mfma_f32_32x32x16_bf16 v[96:111], v[168:171], v[172:175], v[96:111]
    s_waitcnt vmcnt(7)
    s_barrier
    s_add_u32 s9, s81, 5
    s_and_b32 s9, s9, 7
    s_add_u32 m0, s12, 28672
    s_lshl_b32 s8, s9, 7
    buffer_load_dwordx4 v4, s[44:47], s8 offen offset:0 lds
    buffer_load_dwordx4 v5, s[44:47], s8 offen offset:1024 lds
    buffer_load_dwordx4 v6, s[44:47], s8 offen offset:2048 lds
    buffer_load_dwordx4 v7, s[44:47], s8 offen offset:3072 lds
    s_add_u32 m0, s13, 28672
    s_mul_i32 s8, s9, 196608
    buffer_load_dwordx4 v3, s[48:51], s8 offen offset:0 lds
    buffer_load_dwordx4 v3, s[48:51], s8 offen offset:1024 lds
    buffer_load_dwordx4 v3, s[48:51], s8 offen offset:2048 lds
    ds_read_b128 v[144:147], v133 offset:28672
    ds_read_b64_tr_b16 v[148:149], v137 offset:30720
    ds_read_b64_tr_b16 v[150:151], v137 offset:30976
    ds_read_b128 v[152:155], v134 offset:28672
    ds_read_b64_tr_b16 v[156:157], v137 offset:33792
    ds_read_b64_tr_b16 v[158:159], v137 offset:34048
    ds_read_b128 v[160:163], v135 offset:28672
    ds_read_b64_tr_b16 v[164:165], v137 offset:36864
    ds_read_b64_tr_b16 v[166:167], v137 offset:37120
    ds_read_b128 v[168:171], v136 offset:28672
    ds_read_b64_tr_b16 v[172:173], v137 offset:39936
    ds_read_b64_tr_b16 v[174:175], v137 offset:40192
    s_waitcnt lgkmcnt(9)
    v_mfma_f32_32x32x16_bf16 v[96:111], v[144:147], v[148:151], v[96:111]
    s_waitcnt lgkmcnt(6)
    v_mfma_f32_32x32x16_bf16 v[96:111], v[152:155], v[156:159], v[96:111]
    s_waitcnt lgkmcnt(3)
    v_mfma_f32_32x32x16_bf16 v[96:111], v[160:163], v[164:167], v[96:111]
    s_waitcnt lgkmcnt(0)
    v_mfma_f32_32x32x16_bf16 v[96:111], v[168:171], v[172:175], v[96:111]
    v_readfirstlane_b32 s43, v254
    s_nop 1
    s_mul_i32 s43, s43, 0x9e3779b1
    s_add_u32 s43, s43, 0x7f4a7c15
    s_waitcnt vmcnt(7)
    s_barrier
    s_add_u32 s9, s81, 6
    s_and_b32 s9, s9, 7
    s_add_u32 m0, s12, 57344
    s_lshl_b32 s8, s9, 7
    buffer_load_dwordx4 v4, s[44:47], s8 offen offset:0 lds
    buffer_load_dwordx4 v5, s[44:47], s8 offen offset:1024 lds
    buffer_load_dwordx4 v6, s[44:47], s8 offen offset:2048 lds
    buffer_load_dwordx4 v7, s[44:47], s8 offen offset:3072 lds
    s_add_u32 m0, s13, 57344
    s_mul_i32 s8, s9, 196608
    buffer_load_dwordx4 v3, s[48:51], s8 offen offset:0 lds
    buffer_load_dwordx4 v3, s[48:51], s8 offen offset:1024 lds
    buffer_load_dwordx4 v3, s[48:51], s8 offen offset:2048 lds
    ds_read_b128 v[144:147], v128 offset:0
    ds_read_b64_tr_b16 v[148:149], v132 offset:2048
    ds_read_b64_tr_b16 v[150:151], v132 offset:2304
    ds_read_b128 v[152:155], v129 offset:0
    ds_read_b64_tr_b16 v[156:157], v132 offset:5120
    ds_read_b64_tr_b16 v[158:159], v132 offset:5376
    ds_read_b128 v[160:163], v130 offset:0
    ds_read_b64_tr_b16 v[164:165], v132 offset:8192
    ds_read_b64_tr_b16 v[166:167], v132 offset:8448
    ds_read_b128 v[168:171], v131 offset:0
    ds_read_b64_tr_b16 v[172:173], v132 offset:11264
    ds_read_b64_tr_b16 v[174:175], v132 offset:11520
    s_waitcnt lgkmcnt(9)
    v_mfma_f32_32x32x16_bf16 v[96:111], v[144:147], v[148:151], v[96:111]
    s_waitcnt lgkmcnt(6)
    v_mfma_f32_32x32x16_bf16 v[96:111], v[152:155], v[156:159], v[96:111]
    s_waitcnt lgkmcnt(3)
    v_mfma_f32_32x32x16_bf16 v[96:111], v[160:163], v[164:167], v[96:111]
    s_waitcnt lgkmcnt(0)
    v_mfma_f32_32x32x16_bf16 v[96:111], v[168:171], v[172:175], v[96:111]
    s_waitcnt vmcnt(7)
    s_barrier
    s_add_u32 s9, s81, 7
    s_and_b32 s9, s9, 7
    s_add_u32 m0, s12, 86016
    s_lshl_b32 s8, s9, 7
    buffer_load_dwordx4 v4, s[44:47], s8 offen offset:0 lds
    buffer_load_dwordx4 v5, s[44:47], s8 offen offset:1024 lds
    buffer_load_dwordx4 v6, s[44:47], s8 offen offset:2048 lds
    buffer_load_dwordx4 v7, s[44:47], s8 offen offset:3072 lds
    s_add_u32 m0, s13, 86016
    s_mul_i32 s8, s9, 196608
    buffer_load_dwordx4 v3, s[48:51], s8 offen offset:0 lds
    buffer_load_dwordx4 v3, s[48:51], s8 offen offset:1024 lds
    buffer_load_dwordx4 v3, s[48:51], s8 offen offset:2048 lds
    ds_read_b128 v[144:147], v128 offset:28672
    ds_read_b64_tr_b16 v[148:149], v132 offset:30720
    ds_read_b64_tr_b16 v[150:151], v132 offset:30976
    ds_read_b128 v[152:155], v129 offset:28672
    ds_read_b64_tr_b16 v[156:157], v132 offset:33792
    ds_read_b64_tr_b16 v[158:159], v132 offset:34048
    ds_read_b128 v[160:163], v130 offset:28672
    ds_read_b64_tr_b16 v[164:165], v132 offset:36864
    ds_read_b64_tr_b16 v[166:167], v132 offset:37120
    ds_read_b128 v[168:171], v131 offset:28672
    ds_read_b64_tr_b16 v[172:173], v132 offset:39936
    ds_read_b64_tr_b16 v[174:175], v132 offset:40192
    s_waitcnt lgkmcnt(9)
    v_mfma_f32_32x32x16_bf16 v[96:111], v[144:147], v[148:151], v[96:111]
    s_waitcnt lgkmcnt(6)
    v_mfma_f32_32x32x16_bf16 v[96:111], v[152:155], v[156:159], v[96:111]
    s_waitcnt lgkmcnt(3)
    v_mfma_f32_32x32x16_bf16 v[96:111], v[160:163], v[164:167], v[96:111]
    s_waitcnt lgkmcnt(0)
    v_mfma_f32_32x32x16_bf16 v[96:111], v[168:171], v[172:175], v[96:111]
    s_waitcnt vmcnt(7)
    s_barrier
    s_lshr_b32 s8, s15, 1
    s_lshl_b32 s9, s2, 1
    s_add_u32 s9, s9, s8
    s_lshl_b32 s10, s9, 12
    s_add_u32 s72, s30, s10
    s_addc_u32 s73, s31, 0
    s_mov_b32 s74, 4096
    s_mov_b32 s75, 0x20000
    s_and_b32 s8, s15, 1
    s_lshl_b32 s8, s8, 3
    v_lshl_add_u32 v8, v1, 4, s8
    v_lshl_add_u32 v9, v1, 2, s8
    s_mul_i32 s10, s15, 8320
    v_add_u32 v10, 4, v8
    v_add_u32 v11, -60, v9
    s_add_u32 m0, s10, 114752
    s_nop 0
    buffer_load_dwordx4 v10, s[72:75], 0 offen offset:0 lds
    buffer_load_dwordx4 v10, s[72:75], 0 offen offset:1024 lds
    buffer_load_dwordx4 v10, s[72:75], 0 offen offset:2048 lds
    buffer_load_dwordx4 v10, s[72:75], 0 offen offset:3072 lds
    s_add_u32 m0, s10, 114688
    s_mov_b64 exec, 0xffff
    buffer_load_dword v11, s[72:75], 0 offen lds
    s_mov_b64 exec, -1
    v_add_u32 v10, 8, v8
    v_add_u32 v11, -56, v9
    s_add_u32 m0, s10, 118912
    s_nop 0
    buffer_load_dwordx4 v10, s[72:75], 0 offen offset:0 lds
    buffer_load_dwordx4 v10, s[72:75], 0 offen offset:1024 lds
    buffer_load_dwordx4 v10, s[72:75], 0 offen offset:2048 lds
    buffer_load_dwordx4 v10, s[72:75], 0 offen offset:3072 lds
    s_add_u32 m0, s10, 118848
    s_mov_b64 exec, 0xffff
    buffer_load_dword v11, s[72:75], 0 offen lds
    s_mov_b64 exec, -1
    ds_read_b128 v[144:147], v133 offset:0
    ds_read_b64_tr_b16 v[148:149], v137 offset:2048
    ds_read_b64_tr_b16 v[150:151], v137 offset:2304
    ds_read_b128 v[152:155], v134 offset:0
    ds_read_b64_tr_b16 v[156:157], v137 offset:5120
    ds_read_b64_tr_b16 v[158:159], v137 offset:5376
    ds_read_b128 v[160:163], v135 offset:0
    ds_read_b64_tr_b16 v[164:165], v137 offset:8192
    ds_read_b64_tr_b16 v[166:167], v137 offset:8448
    ds_read_b128 v[168:171], v136 offset:0
    ds_read_b64_tr_b16 v[172:173], v137 offset:11264
    ds_read_b64_tr_b16 v[174:175], v137 offset:11520
    s_waitcnt lgkmcnt(9)
    v_mfma_f32_32x32x16_bf16 v[96:111], v[144:147], v[148:151], v[96:111]
    s_waitcnt lgkmcnt(6)
    v_mfma_f32_32x32x16_bf16 v[96:111], v[152:155], v[156:159], v[96:111]
    s_waitcnt lgkmcnt(3)
    v_mfma_f32_32x32x16_bf16 v[96:111], v[160:163], v[164:167], v[96:111]
    s_waitcnt lgkmcnt(0)
    v_mfma_f32_32x32x16_bf16 v[96:111], v[168:171], v[172:175], v[96:111]
    s_waitcnt vmcnt(10)
    s_barrier
    v_lshlrev_b32 v245, 4, v1
    v_lshrrev_b32 v60, 5, v1
    v_lshlrev_b32 v60, 4, v60
    v_and_or_b32 v60, v1, 15, v60
    v_lshlrev_b32 v60, 4, v60
    s_lshl_b32 s10, s3, 11
    v_add_u32 v68, s10, v245
    v_add_u32 v69, s10, v60
    v_and_b32 v61, 27, v1
    v_cmp_eq_u32 vcc, 16, v61
    v_mov_b32 v61, 0x3f803f80
    v_mov_b32 v62, 1040
    v_cndmask_b32 v61, 0, v61, vcc
    v_mov_b32 v63, 1024
    v_cndmask_b32 v246, v62, v63, vcc
    v_add_u32 v247, 0xfffffe00, v246
    v_and_b32 v62, 16, v1
    v_cmp_eq_u32 vcc, 0, v62
    v_mov_b32 v244, 0xdddddddd
    s_mul_i32 s10, s3, 2176
    v_cndmask_b32 v246, v246, v60, vcc
    v_cndmask_b32 v247, v247, v60, vcc
    s_lshl_b32 s11, s80, 15
    s_add_u32 s88, s10, s11
    s_add_u32 s88, s88, s40
    s_addc_u32 s39, s41, 0
    s_mov_b32 s89, 0
    v_mov_b32 v212, v61
    v_mov_b32 v213, v61
    v_mov_b32 v214, v61
    v_mov_b32 v215, v61
    v_mov_b32 v216, v61
    v_mov_b32 v217, v61
    v_mov_b32 v218, v61
    v_mov_b32 v219, v61
    s_lshr_b32 s10, s3, 2
    s_lshl_b32 s10, s10, 12
    s_add_u32 s10, s10, 147968
    s_add_u32 s11, s15, 0
    s_and_b32 s11, s11, 3
    s_lshl_b32 s11, s11, 10
    s_add_u32 s11, s11, s10
    v_add_u32 v64, s11, v245
    s_add_u32 s11, s15, 1
    s_and_b32 s11, s11, 3
    s_lshl_b32 s11, s11, 10
    s_add_u32 s11, s11, s10
    v_add_u32 v65, s11, v245
    s_add_u32 s11, s15, 2
    s_and_b32 s11, s11, 3
    s_lshl_b32 s11, s11, 10
    s_add_u32 s11, s11, s10
    v_add_u32 v66, s11, v245
    s_add_u32 s11, s15, 3
    s_and_b32 s11, s11, 3
    s_lshl_b32 s11, s11, 10
    s_add_u32 s11, s11, s10
    v_add_u32 v67, s11, v245
    v_and_b32 v70, 3, v1
    v_lshlrev_b32 v70, 2, v70
    v_add_u32 v70, 156160, v70
    ds_read_b128 v[144:147], v133 offset:28672
    ds_read_b64_tr_b16 v[148:149], v137 offset:30720
    ds_read_b64_tr_b16 v[150:151], v137 offset:30976
    ds_read_b128 v[152:155], v134 offset:28672
    ds_read_b64_tr_b16 v[156:157], v137 offset:33792
    ds_read_b64_tr_b16 v[158:159], v137 offset:34048
    ds_read_b128 v[160:163], v135 offset:28672
    ds_read_b64_tr_b16 v[164:165], v137 offset:36864
    ds_read_b64_tr_b16 v[166:167], v137 offset:37120
    ds_read_b128 v[168:171], v136 offset:28672
    ds_read_b64_tr_b16 v[172:173], v137 offset:39936
    ds_read_b64_tr_b16 v[174:175], v137 offset:40192
    s_waitcnt lgkmcnt(9)
    v_mfma_f32_32x32x16_bf16 v[96:111], v[144:147], v[148:151], v[96:111]
    s_waitcnt lgkmcnt(6)
    v_mfma_f32_32x32x16_bf16 v[96:111], v[152:155], v[156:159], v[96:111]
    s_waitcnt lgkmcnt(3)
    v_mfma_f32_32x32x16_bf16 v[96:111], v[160:163], v[164:167], v[96:111]
    s_waitcnt lgkmcnt(0)
    v_mfma_f32_32x32x16_bf16 v[96:111], v[168:171], v[172:175], v[96:111]
    s_mul_i32 s8, s80, 32768
    s_mul_i32 s11, s15, 2176
    s_add_u32 s8, s8, s11
    v_bfe_u32 v38, v1, 4, 1
    v_lshrrev_b32 v37, 5, v1
    v_lshlrev_b32 v37, 8, v37
    v_and_b32 v39, 15, v1
    v_lshl_add_u32 v37, v39, 4, v37
    s_movk_i32 s12, 8704
    v_mad_u32_u24 v36, v38, s12, v37
    v_lshl_add_u32 v37, v38, 13, v37
    s_lshl_b32 s10, s15, 11
    v_add_u32 v37, s10, v37
    v_and_b32 v39, 1, v1
    v_mul_u32_u24 v39, 8704, v39
    v_and_b32 v24, 2, v1
    v_lshl_add_u32 v39, v24, 3, v39
    v_cmp_eq_u32 vcc, 0, v24
    v_mov_b32 v25, 0x3f803f80
    s_nop 0
    v_cndmask_b32 v24, 0, v25, vcc
    v_mov_b32 v25, v24
    v_mov_b32 v26, v24
    v_mov_b32 v27, v24
    v_cvt_pk_bf16_f32 v16, v96, v97
    v_cvt_pk_bf16_f32 v17, v98, v99
    v_cvt_pk_bf16_f32 v18, v100, v101
    v_cvt_pk_bf16_f32 v19, v102, v103
    v_cvt_pk_bf16_f32 v20, v104, v105
    v_cvt_pk_bf16_f32 v21, v106, v107
    v_cvt_pk_bf16_f32 v22, v108, v109
    v_cvt_pk_bf16_f32 v23, v110, v111
    buffer_store_dwordx4 v[16:19], v36, s[68:71], s8 offen offset:1024 sc1
    buffer_store_dwordx4 v[20:23], v36, s[68:71], s8 offen offset:1536 sc1
    s_mov_b64 exec, 15
    buffer_store_dwordx4 v[24:27], v39, s[68:71], s8 offen offset:2048 sc1
    s_mov_b64 exec, -1
    ds_write_b128 v37, v[16:19] offset:29696
    ds_write_b128 v37, v[20:23] offset:30208
    s_waitcnt lgkmcnt(0)
    s_barrier
    v_add_u32 v28, 4294959104, v68
    ds_read_b128 v[44:47], v28 offset:28672
    ds_read_b128 v[208:211], v68 offset:28672
    ds_read_b128 v[192:195], v64
    ds_read_b128 v[196:199], v65
    ds_read_b128 v[200:203], v66
    ds_read_b128 v[204:207], v67
    s_mov_b32 exec_lo, 0xffff
    s_mov_b32 exec_hi, 0xffff
    ds_read_b128 v[212:215], v69 offset:29696
    ds_read_b128 v[216:219], v69 offset:30208
    s_mov_b64 exec, -1
    ds_read_b32 v42, v70
    ds_read_b32 v41, v70 offset:32
    s_mul_i32 s8, s80, 32768
    s_mul_i32 s11, s15, 2176
    s_add_u32 s8, s8, s11
    s_add_u32 s9, s8, 8704
    s_waitcnt lgkmcnt(9)
    buffer_store_dwordx4 v[44:47], v245, s[68:71], s8 offen sc1
    s_waitcnt lgkmcnt(8)
    buffer_store_dwordx4 v[208:211], v245, s[68:71], s9 offen sc1
    v_mov_b32 v32, 0
    v_mov_b32 v33, 0
    v_mov_b32 v34, 0
    v_mov_b32 v35, 0
    s_nop 1
    v_mfma_f32_32x32x16_bf16 v[64:79], v[32:35], v[32:35], 0
    v_mfma_f32_32x32x16_bf16 v[80:95], v[32:35], v[32:35], 0
    v_mfma_f32_32x32x16_bf16 v[96:111], v[32:35], v[32:35], 0
    v_mfma_f32_32x32x16_bf16 v[112:127], v[32:35], v[32:35], 0
    s_waitcnt lgkmcnt(0)
    v_max_f32_dpp v42, v42, v42 row_shr:1 row_mask:0xf bank_mask:0xf
    v_max_f32_dpp v41, v41, v41 row_shr:1 row_mask:0xf bank_mask:0xf
    s_nop 0
    v_max_f32_dpp v42, v42, v42 row_shr:2 row_mask:0xf bank_mask:0xf
    v_max_f32_dpp v41, v41, v41 row_shr:2 row_mask:0xf bank_mask:0xf
    v_mfma_f32_32x32x16_bf16 v[128:143], v[208:211], v[192:195], 0
    v_mfma_f32_32x32x16_bf16 v[144:159], v[208:211], v[196:199], 0
    s_nop 10
    v_exp_f32 v128, v128
    v_exp_f32 v129, v129
    v_exp_f32 v130, v130
    v_exp_f32 v131, v131
    v_exp_f32 v132, v132
    v_exp_f32 v133, v133
    v_exp_f32 v134, v134
    v_exp_f32 v135, v135
    v_exp_f32 v136, v136
    v_exp_f32 v137, v137
    v_smfmac_f32_32x32x32_bf16 v[64:79], v[212:215], v[128:135], v244
    v_exp_f32 v138, v138
    v_exp_f32 v139, v139
    v_exp_f32 v140, v140
    v_exp_f32 v141, v141
    v_exp_f32 v142, v142
    v_exp_f32 v143, v143
    v_mfma_f32_32x32x16_bf16 v[160:175], v[208:211], v[200:203], 0
    v_exp_f32 v144, v144
    v_exp_f32 v145, v145
    v_exp_f32 v146, v146
    v_exp_f32 v147, v147
    v_smfmac_f32_32x32x32_bf16 v[64:79], v[216:219], v[136:143], v244
    v_exp_f32 v148, v148
    v_exp_f32 v149, v149
    v_exp_f32 v150, v150
    v_exp_f32 v151, v151
    v_exp_f32 v152, v152
    v_exp_f32 v153, v153
    v_smfmac_f32_32x32x32_bf16 v[80:95], v[212:215], v[144:151], v244
    v_exp_f32 v154, v154
    v_exp_f32 v155, v155
    v_exp_f32 v156, v156
    v_exp_f32 v157, v157
    v_exp_f32 v158, v158
    v_exp_f32 v159, v159
    v_mfma_f32_32x32x16_bf16 v[176:191], v[208:211], v[204:207], 0
    v_exp_f32 v160, v160
    v_exp_f32 v161, v161
    v_exp_f32 v162, v162
    v_exp_f32 v163, v163
    v_smfmac_f32_32x32x32_bf16 v[80:95], v[216:219], v[152:159], v244
    v_exp_f32 v164, v164
    v_exp_f32 v165, v165
    v_exp_f32 v166, v166
    v_exp_f32 v167, v167
    v_exp_f32 v168, v168
    v_exp_f32 v169, v169
    v_smfmac_f32_32x32x32_bf16 v[96:111], v[212:215], v[160:167], v244
    v_exp_f32 v170, v170
    v_exp_f32 v171, v171
    v_exp_f32 v172, v172
    v_exp_f32 v173, v173
    v_exp_f32 v174, v174
    v_exp_f32 v175, v175
    v_exp_f32 v176, v176
    v_exp_f32 v177, v177
    v_exp_f32 v178, v178
    v_exp_f32 v179, v179
    v_smfmac_f32_32x32x32_bf16 v[96:111], v[216:219], v[168:175], v244
    v_exp_f32 v180, v180
    v_exp_f32 v181, v181
    v_exp_f32 v182, v182
    v_exp_f32 v183, v183
    v_exp_f32 v184, v184
    v_exp_f32 v185, v185
    v_smfmac_f32_32x32x32_bf16 v[112:127], v[212:215], v[176:183], v244
    v_exp_f32 v186, v186
    v_exp_f32 v187, v187
    v_exp_f32 v188, v188
    v_exp_f32 v189, v189
    v_exp_f32 v190, v190
    v_exp_f32 v191, v191
    s_waitcnt vmcnt(5)
    s_waitcnt vmcnt(0)
    v_mov_b32 v10, 163776
    v_mov_b32 v11, 1
    s_lshl_b64 exec, 1, 63
    ds_add_rtn_u32 v11, v10, v11
    s_waitcnt lgkmcnt(0)
    v_cmp_eq_u32 vcc, 3, v11
    s_cbranch_vccz L_sigv
    s_lshl_b32 s8, s80, 7
    s_add_u32 s8, s8, 14745600
    v_mov_b32 v40, s43
    v_mov_b32 v10, 0
    buffer_store_dwordx2 v[40:41], v10, s[68:71], s8 offen sc1
L_sigv:
    s_mov_b64 exec, -1
    s_barrier
    s_mov_b32 s48, s20
    s_mov_b32 s49, s21
    s_mov_b32 s50, 524288
    s_mov_b32 s51, 0x20000
    s_lshr_b32 s8, s2, 5
    s_lshl_b32 s8, s8, 3
    s_and_b32 s84, s2, 7
    s_add_u32 s84, s84, s8
    s_bfe_u32 s85, s2, 0x20003
    s_lshl_b32 s10, s2, 2
    s_load_dword s42, s[32:33], s10
    v_and_b32 v60, 3, v1
    v_mul_u32_u24 v248, 4160, v60
    v_bfe_u32 v60, v1, 2, 2
    v_lshrrev_b32 v61, 4, v1
    v_add_u32 v60, v60, v61
    v_lshl_add_u32 v248, v60, 4, v248
    s_lshr_b32 s8, s15, 1
    s_and_b32 s9, s3, 1
    s_lshl_b32 s9, s9, 8
    s_mul_i32 s10, s8, 16640
    s_add_u32 s10, s10, s9
    s_add_u32 s10, s10, 114688
    v_add_u32 v248, s10, v248
    v_and_b32 v60, 1, v1
    v_mul_u32_u24 v249, 4576, v60
    v_lshl_add_u32 v249, v61, 4, v249
    v_bfe_u32 v60, v1, 1, 3
    v_lshlrev_b32 v60, 6, v60
    v_sub_u32 v249, v249, v60
    v_add_u32 v250, 4080, v249
    v_lshlrev_b32 v62, 5, v61
    v_sub_u32 v250, v250, v62
    s_lshl_b32 s11, s3, 9
    v_subrev_u32 v250, s11, v250
    s_mul_i32 s10, s8, 9152
    s_add_u32 s10, s10, s9
    s_add_u32 s10, s10, 448
    v_add_u32 v249, s10, v249
    s_waitcnt lgkmcnt(0)
    v_mov_b32 v16, -1
    v_mov_b32 v17, -1
    v_mov_b32 v18, -1
    v_mov_b32 v19, -1
    s_lshl_b32 s93, s5, 2
    s_add_u32 s93, s93, s15
    s_lshl_b32 s93, s93, 1
    s_lshr_b32 s9, s3, 2
    s_add_u32 s93, s93, s9
    s_lshl_b32 s93, s93, 4
    s_add_u32 s93, s93, s4
    s_lshl_b32 s93, s93, 10
    s_add_u32 s93, s93, 12582912
    s_sub_u32 s10, s93, 16384
    buffer_store_dwordx4 v[16:19], v245, s[68:71], s93 offen sc1
    buffer_store_dwordx4 v[16:19], v245, s[68:71], s10 offen sc1
    s_cmp_ge_u32 s3, 6
    s_cbranch_scc1 L_nowopf
    s_lshr_b32 s8, s2, 5
    s_lshl_b32 s8, s8, 1
    s_add_u32 s8, s8, s15
    s_lshl_b32 s8, s8, 15
    s_lshl_b32 s9, s85, 8
    s_add_u32 s8, s8, s9
    v_lshrrev_b32 v10, 1, v1
    v_lshlrev_b32 v10, 10, v10
    v_and_b32 v11, 1, v1
    v_lshl_add_u32 v10, v11, 7, v10
    buffer_load_dword v252, v10, s[48:51], s8 offen
L_nowopf:
    s_lshl_b32 s10, s85, 2
    s_add_u32 s10, s10, s15
    s_lshl_b32 s9, s10, 6
    v_lshrrev_b32 v24, 2, v1
    v_lshlrev_b32 v24, 10, v24
    v_and_b32 v25, 3, v1
    v_lshl_add_u32 v24, v25, 4, v24
    v_add_u32 v60, s9, v24
    v_add_u32 v61, 15360, v60
    v_add_u32 v62, 30720, v60
    v_add_u32 v63, 46080, v60
    s_lshl_b32 s95, s15, 15
    s_mov_b32 s92, 0
    s_lshl_b32 s94, s4, 11
    s_add_u32 s94, s94, 14745600
    v_and_b32 v14, 15, v1
    v_cmp_eq_u32 vcc, s5, v14
    v_xor_b32 v15, 1, v14
    s_nop 0
    v_cndmask_b32 v14, v14, v15, vcc
    v_lshlrev_b32 v14, 7, v14
    buffer_load_dwordx2 v[12:13], v14, s[68:71], s94 offen sc1
    s_mov_b32 s82, 262144
    s_waitcnt vmcnt(0)
    s_branch L_pollkv_chk
L_pollkv:
    buffer_load_dwordx2 v[12:13], v14, s[68:71], s94 offen sc1
    s_waitcnt vmcnt(0)
L_pollkv_chk:
    v_cmp_ne_u32 vcc, s43, v12
    s_cbranch_vccz L_pollkv_ok
    s_sub_u32 s82, s82, 1
    s_cbranch_scc0 L_pollkv
L_pollkv_ok:
    s_add_u32 s89, s89, 32768
    s_xor_b32 s38, s88, s89
    global_load_dwordx4 v[220:223], v245, s[38:39] sc1
    global_load_dwordx4 v[224:227], v246, s[38:39] offset:1024 sc1
    global_load_dwordx4 v[228:231], v247, s[38:39] offset:1536 sc1
    s_add_u32 s89, s89, 32768
    s_xor_b32 s38, s88, s89
    global_load_dwordx4 v[232:235], v245, s[38:39] sc1
    global_load_dwordx4 v[236:239], v246, s[38:39] offset:1024 sc1
    global_load_dwordx4 v[240:243], v247, s[38:39] offset:1536 sc1
    v_max_f32_dpp v13, v13, v13 row_shr:1 row_mask:0xf bank_mask:0xf
    s_nop 1
    v_max_f32_dpp v13, v13, v13 row_shr:2 row_mask:0xf bank_mask:0xf
    s_nop 1
    v_max_f32_dpp v13, v13, v13 row_shr:4 row_mask:0xf bank_mask:0xf
    s_nop 1
    v_max_f32_dpp v13, v13, v13 row_shr:8 row_mask:0xf bank_mask:0xf
    v_max_f32 v13, v13, v41
    v_mul_f32 v11, v42, v13
    v_mov_b32 v10, 156176
    s_lshl_b64 exec, 1, 63
    ds_write_b32 v10, v11
    s_mov_b64 exec, -1
    s_waitcnt lgkmcnt(0)
    s_barrier
L_join:
    s_lshl_b32 s9, s3, 10
    s_add_u32 s9, s9, 57344
    v_add_u32 v2, s9, v245
    v_mov_b32 v10, 156176
    ds_read_b32 v11, v10
    ds_read_b128 v[32:35], v2 offset:0
    ds_read_b128 v[36:39], v2 offset:8192
    ds_read_b128 v[40:43], v2 offset:16384
    ds_read_b128 v[44:47], v2 offset:24576
    ds_read_b128 v[144:147], v250 offset:0
    ds_read_b128 v[148:151], v250 offset:9152
    v_bfe_u32 v2, v1, 1, 3
    v_lshlrev_b32 v2, 7, v2
    v_lshrrev_b32 v59, 4, v1
    v_lshl_add_u32 v2, v59, 5, v2
    v_and_b32 v10, 1, v1
    v_lshl_add_u32 v2, v10, 4, v2
    s_mul_i32 s8, s2, 8448
    s_lshl_b32 s9, s3, 10
    s_add_u32 s8, s8, s9
    s_add_u32 s8, s8, 9437184
    s_lshl_b32 s9, s42, 16
    s_and_b32 s10, s42, 0xffff0000
    v_mov_b32 v10, 1147207680
    s_lshl_b32 s93, s5, 2
    s_add_u32 s93, s93, s15
    s_lshl_b32 s93, s93, 1
    s_lshr_b32 s94, s3, 2
    s_add_u32 s93, s93, s94
    s_lshl_b32 s93, s93, 4
    s_add_u32 s93, s93, s4
    s_lshl_b32 s93, s93, 10
    s_add_u32 s93, s93, 12582912
    s_waitcnt lgkmcnt(0)
    s_barrier
    v_add_f32 v32, v32, v36
    v_lshlrev_b32 v147, 16, v147
    v_add_f32 v33, v33, v37
    v_lshlrev_b32 v146, 16, v146
    v_add_f32 v34, v34, v38
    v_lshlrev_b32 v145, 16, v145
    v_add_f32 v35, v35, v39
    v_lshlrev_b32 v144, 16, v144
    v_fmac_f32 v32, s9, v147
    v_fmac_f32 v33, s9, v146
    v_fmac_f32 v34, s9, v145
    v_fmac_f32 v35, s9, v144
    v_add_f32 v40, v40, v44
    v_lshlrev_b32 v151, 16, v151
    v_add_f32 v41, v41, v45
    v_lshlrev_b32 v150, 16, v150
    v_add_f32 v42, v42, v46
    v_lshlrev_b32 v149, 16, v149
    v_add_f32 v43, v43, v47
    v_lshlrev_b32 v148, 16, v148
    v_fmac_f32 v40, s10, v151
    v_fmac_f32 v41, s10, v150
    v_fmac_f32 v42, s10, v149
    v_fmac_f32 v43, s10, v148
    v_cvt_pk_bf16_f32 v20, v32, v40
    v_cvt_pk_bf16_f32 v21, v33, v41
    v_cvt_pk_bf16_f32 v22, v34, v42
    v_cvt_pk_bf16_f32 v23, v35, v43
    buffer_store_dwordx4 v[20:23], v2, s[68:71], s8 offen sc1
    s_and_b32 s8, s3, 4
    s_add_u32 s8, s8, 163776
    v_mov_b32 v58, s8
    s_sub_u32 s8, s15, 0
    s_and_b32 s8, s8, 3
    s_mul_i32 s10, s8, 6912
    s_add_u32 s10, s10, 131072
    v_add_u32 v56, s10, v245
    v_lshl_add_u32 v57, v1, 2, s10
    s_sub_u32 s8, s15, 1
    s_and_b32 s8, s8, 3
    s_mul_i32 s10, s8, 6912
    s_add_u32 s10, s10, 131072
    v_add_u32 v49, s10, v245
    v_lshl_add_u32 v53, v1, 2, s10
    s_sub_u32 s8, s15, 2
    s_and_b32 s8, s8, 3
    s_mul_i32 s10, s8, 6912
    s_add_u32 s10, s10, 131072
    v_add_u32 v50, s10, v245
    v_lshl_add_u32 v54, v1, 2, s10
    s_sub_u32 s8, s15, 3
    s_and_b32 s8, s8, 3
    s_mul_i32 s10, s8, 6912
    s_add_u32 s10, s10, 131072
    v_add_u32 v51, s10, v245
    v_lshl_add_u32 v55, v1, 2, s10
    s_setprio 1
    v_cmp_le_f32 vcc, v11, v10
    s_cbranch_vccz L_slow
    s_or_b32 s91, s3, 4
    s_add_u32 s91, s91, 64
    s_add_u32 s8, s3, 64
    s_waitcnt vmcnt(4)
    v_mfma_f32_32x32x16_bf16 v[128:143], v[220:223], v[192:195], 0
    s_nop 10
L_loop:
    v_mfma_f32_32x32x16_bf16 v[144:159], v[220:223], v[196:199], 0
    s_add_u32 s89, s89, 32768
    s_xor_b32 s38, s88, s89
    v_exp_f32 v128, v128
    v_exp_f32 v129, v129
    v_exp_f32 v130, v130
    v_exp_f32 v131, v131
    v_smfmac_f32_32x32x32_bf16 v[112:127], v[216:219], v[184:191], v244
    global_load_dwordx4 v[208:211], v245, s[38:39] sc1
    global_load_dwordx4 v[212:215], v246, s[38:39] offset:1024 sc1
    global_load_dwordx4 v[216:219], v247, s[38:39] offset:1536 sc1
    s_cmp_eq_u32 s91, s8
    s_cbranch_scc1 L_hook
L_back:
    v_exp_f32 v132, v132
    v_exp_f32 v133, v133
    v_exp_f32 v134, v134
    v_exp_f32 v135, v135
    v_exp_f32 v136, v136
    v_exp_f32 v137, v137
    v_smfmac_f32_32x32x32_bf16 v[64:79], v[224:227], v[128:135], v244
    v_exp_f32 v138, v138
    v_exp_f32 v139, v139
    v_exp_f32 v140, v140
    v_exp_f32 v141, v141
    v_exp_f32 v142, v142
    v_exp_f32 v143, v143
    v_mfma_f32_32x32x16_bf16 v[160:175], v[220:223], v[200:203], 0
    v_exp_f32 v144, v144
    v_exp_f32 v145, v145
    v_exp_f32 v146, v146
    v_exp_f32 v147, v147
    v_smfmac_f32_32x32x32_bf16 v[64:79], v[228:231], v[136:143], v244
    v_exp_f32 v148, v148
    v_exp_f32 v149, v149
    v_exp_f32 v150, v150
    v_exp_f32 v151, v151
    v_exp_f32 v152, v152
    v_exp_f32 v153, v153
    v_smfmac_f32_32x32x32_bf16 v[80:95], v[224:227], v[144:151], v244
    v_exp_f32 v154, v154
    v_exp_f32 v155, v155
    v_exp_f32 v156, v156
    v_exp_f32 v157, v157
    v_exp_f32 v158, v158
    v_exp_f32 v159, v159
    v_mfma_f32_32x32x16_bf16 v[176:191], v[220:223], v[204:207], 0
    v_exp_f32 v160, v160
    v_exp_f32 v161, v161
    v_exp_f32 v162, v162
    v_exp_f32 v163, v163
    v_smfmac_f32_32x32x32_bf16 v[80:95], v[228:231], v[152:159], v244
    v_exp_f32 v164, v164
    v_exp_f32 v165, v165
    v_exp_f32 v166, v166
    v_exp_f32 v167, v167
    v_exp_f32 v168, v168
    v_exp_f32 v169, v169
    v_smfmac_f32_32x32x32_bf16 v[96:111], v[224:227], v[160:167], v244
    v_exp_f32 v170, v170
    v_exp_f32 v171, v171
    v_exp_f32 v172, v172
    v_exp_f32 v173, v173
    v_exp_f32 v174, v174
    v_exp_f32 v175, v175
    s_waitcnt vmcnt(3)
    v_mfma_f32_32x32x16_bf16 v[128:143], v[232:235], v[192:195], 0
    v_exp_f32 v176, v176
    v_exp_f32 v177, v177
    v_exp_f32 v178, v178
    v_exp_f32 v179, v179
    v_smfmac_f32_32x32x32_bf16 v[96:111], v[228:231], v[168:175], v244
    v_exp_f32 v180, v180
    v_exp_f32 v181, v181
    v_exp_f32 v182, v182
    v_exp_f32 v183, v183
    v_exp_f32 v184, v184
    v_exp_f32 v185, v185
    v_smfmac_f32_32x32x32_bf16 v[112:127], v[224:227], v[176:183], v244
    v_exp_f32 v186, v186
    v_exp_f32 v187, v187
    v_exp_f32 v188, v188
    v_exp_f32 v189, v189
    v_exp_f32 v190, v190
    v_exp_f32 v191, v191
    v_mfma_f32_32x32x16_bf16 v[144:159], v[232:235], v[196:199], 0
    s_add_u32 s89, s89, 32768
    s_xor_b32 s38, s88, s89
    v_exp_f32 v128, v128
    v_exp_f32 v129, v129
    v_exp_f32 v130, v130
    v_exp_f32 v131, v131
    v_smfmac_f32_32x32x32_bf16 v[112:127], v[228:231], v[184:191], v244
    global_load_dwordx4 v[220:223], v245, s[38:39] sc1
    global_load_dwordx4 v[224:227], v246, s[38:39] offset:1024 sc1
    global_load_dwordx4 v[228:231], v247, s[38:39] offset:1536 sc1
    v_exp_f32 v132, v132
    v_exp_f32 v133, v133
    v_exp_f32 v134, v134
    v_exp_f32 v135, v135
    v_exp_f32 v136, v136
    v_exp_f32 v137, v137
    v_smfmac_f32_32x32x32_bf16 v[64:79], v[236:239], v[128:135], v244
    v_exp_f32 v138, v138
    v_exp_f32 v139, v139
    v_exp_f32 v140, v140
    v_exp_f32 v141, v141
    v_exp_f32 v142, v142
    v_exp_f32 v143, v143
    v_mfma_f32_32x32x16_bf16 v[160:175], v[232:235], v[200:203], 0
    v_exp_f32 v144, v144
    v_exp_f32 v145, v145
    v_exp_f32 v146, v146
    v_exp_f32 v147, v147
    v_smfmac_f32_32x32x32_bf16 v[64:79], v[240:243], v[136:143], v244
    v_exp_f32 v148, v148
    v_exp_f32 v149, v149
    v_exp_f32 v150, v150
    v_exp_f32 v151, v151
    v_exp_f32 v152, v152
    v_exp_f32 v153, v153
    v_smfmac_f32_32x32x32_bf16 v[80:95], v[236:239], v[144:151], v244
    v_exp_f32 v154, v154
    v_exp_f32 v155, v155
    v_exp_f32 v156, v156
    v_exp_f32 v157, v157
    v_exp_f32 v158, v158
    v_exp_f32 v159, v159
    v_mfma_f32_32x32x16_bf16 v[176:191], v[232:235], v[204:207], 0
    v_exp_f32 v160, v160
    v_exp_f32 v161, v161
    v_exp_f32 v162, v162
    v_exp_f32 v163, v163
    v_smfmac_f32_32x32x32_bf16 v[80:95], v[240:243], v[152:159], v244
    v_exp_f32 v164, v164
    v_exp_f32 v165, v165
    v_exp_f32 v166, v166
    v_exp_f32 v167, v167
    v_exp_f32 v168, v168
    v_exp_f32 v169, v169
    v_smfmac_f32_32x32x32_bf16 v[96:111], v[236:239], v[160:167], v244
    v_exp_f32 v170, v170
    v_exp_f32 v171, v171
    v_exp_f32 v172, v172
    v_exp_f32 v173, v173
    v_exp_f32 v174, v174
    v_exp_f32 v175, v175
    s_waitcnt vmcnt(3)
    v_mfma_f32_32x32x16_bf16 v[128:143], v[208:211], v[192:195], 0
    v_exp_f32 v176, v176
    v_exp_f32 v177, v177
    v_exp_f32 v178, v178
    v_exp_f32 v179, v179
    v_smfmac_f32_32x32x32_bf16 v[96:111], v[240:243], v[168:175], v244
    v_exp_f32 v180, v180
    v_exp_f32 v181, v181
    v_exp_f32 v182, v182
    v_exp_f32 v183, v183
    v_exp_f32 v184, v184
    v_exp_f32 v185, v185
    v_smfmac_f32_32x32x32_bf16 v[112:127], v[236:239], v[176:183], v244
    v_exp_f32 v186, v186
    v_exp_f32 v187, v187
    v_exp_f32 v188, v188
    v_exp_f32 v189, v189
    v_exp_f32 v190, v190
    v_exp_f32 v191, v191
    v_mfma_f32_32x32x16_bf16 v[144:159], v[208:211], v[196:199], 0
    s_add_u32 s89, s89, 32768
    s_xor_b32 s38, s88, s89
    v_exp_f32 v128, v128
    v_exp_f32 v129, v129
    v_exp_f32 v130, v130
    v_exp_f32 v131, v131
    v_smfmac_f32_32x32x32_bf16 v[112:127], v[240:243], v[184:191], v244
    global_load_dwordx4 v[232:235], v245, s[38:39] sc1
    global_load_dwordx4 v[236:239], v246, s[38:39] offset:1024 sc1
    global_load_dwordx4 v[240:243], v247, s[38:39] offset:1536 sc1
    v_exp_f32 v132, v132
    v_exp_f32 v133, v133
    v_exp_f32 v134, v134
    v_exp_f32 v135, v135
    v_exp_f32 v136, v136
    v_exp_f32 v137, v137
    v_smfmac_f32_32x32x32_bf16 v[64:79], v[212:215], v[128:135], v244
    v_exp_f32 v138, v138
    v_exp_f32 v139, v139
    v_exp_f32 v140, v140
    v_exp_f32 v141, v141
    v_exp_f32 v142, v142
    v_exp_f32 v143, v143
    v_mfma_f32_32x32x16_bf16 v[160:175], v[208:211], v[200:203], 0
    v_exp_f32 v144, v144
    v_exp_f32 v145, v145
    v_exp_f32 v146, v146
    v_exp_f32 v147, v147
    v_smfmac_f32_32x32x32_bf16 v[64:79], v[216:219], v[136:143], v244
    v_exp_f32 v148, v148
    v_exp_f32 v149, v149
    v_exp_f32 v150, v150
    v_exp_f32 v151, v151
    v_exp_f32 v152, v152
    v_exp_f32 v153, v153
    v_smfmac_f32_32x32x32_bf16 v[80:95], v[212:215], v[144:151], v244
    v_exp_f32 v154, v154
    v_exp_f32 v155, v155
    v_exp_f32 v156, v156
    v_exp_f32 v157, v157
    v_exp_f32 v158, v158
    v_exp_f32 v159, v159
    v_mfma_f32_32x32x16_bf16 v[176:191], v[208:211], v[204:207], 0
    v_exp_f32 v160, v160
    v_exp_f32 v161, v161
    v_exp_f32 v162, v162
    v_exp_f32 v163, v163
    v_smfmac_f32_32x32x32_bf16 v[80:95], v[216:219], v[152:159], v244
    v_exp_f32 v164, v164
    v_exp_f32 v165, v165
    v_exp_f32 v166, v166
    v_exp_f32 v167, v167
    v_exp_f32 v168, v168
    v_exp_f32 v169, v169
    v_smfmac_f32_32x32x32_bf16 v[96:111], v[212:215], v[160:167], v244
    v_exp_f32 v170, v170
    v_exp_f32 v171, v171
    v_exp_f32 v172, v172
    v_exp_f32 v173, v173
    v_exp_f32 v174, v174
    v_exp_f32 v175, v175
    s_waitcnt vmcnt(3)
    v_mfma_f32_32x32x16_bf16 v[128:143], v[220:223], v[192:195], 0
    v_exp_f32 v176, v176
    v_exp_f32 v177, v177
    v_exp_f32 v178, v178
    v_exp_f32 v179, v179
    v_smfmac_f32_32x32x32_bf16 v[96:111], v[216:219], v[168:175], v244
    v_exp_f32 v180, v180
    v_exp_f32 v181, v181
    v_exp_f32 v182, v182
    v_exp_f32 v183, v183
    v_exp_f32 v184, v184
    v_exp_f32 v185, v185
    v_smfmac_f32_32x32x32_bf16 v[112:127], v[212:215], v[176:183], v244
    v_exp_f32 v186, v186
    v_exp_f32 v187, v187
    v_exp_f32 v188, v188
    v_exp_f32 v189, v189
    v_exp_f32 v190, v190
    v_exp_f32 v191, v191
    s_sub_u32 s91, s91, 16
    s_cbranch_scc0 L_loop
    v_smfmac_f32_32x32x32_bf16 v[112:127], v[216:219], v[184:191], v244
    s_cmp_ge_u32 s3, 4
    s_cbranch_scc1 L_xff_go
    s_nop 3
    s_branch L_xff_ok
L_xff_go:
    s_mov_b32 s82, 2097152
L_xff:
    ds_read_b32 v10, v58 offset:8
    s_waitcnt lgkmcnt(0)
    v_cmp_gt_u32 vcc, 4, v10
    s_cbranch_vccz L_xff_ok
    s_sub_u32 s82, s82, 1
    s_cbranch_scc0 L_xff
L_xff_ok:
    ds_write_b128 v56, v[80:83] offset:0
    ds_write_b128 v56, v[84:87] offset:1024
    ds_write_b32 v57, v88 offset:2048
    ds_write_b128 v56, v[96:99] offset:2304
    ds_write_b128 v56, v[100:103] offset:3328
    ds_write_b32 v57, v104 offset:4352
    ds_write_b128 v56, v[112:115] offset:4608
    ds_write_b128 v56, v[116:119] offset:5632
    ds_write_b32 v57, v120 offset:6656
    v_mov_b32 v10, 1
    s_mov_b64 exec, 1
    ds_add_u32 v58, v10 offset:4
    s_mov_b64 exec, -1
    s_mov_b32 s82, 2097152
L_xsf:
    ds_read_b32 v10, v58 offset:4
    s_waitcnt lgkmcnt(0)
    v_cmp_gt_u32 vcc, 4, v10
    s_cbranch_vccz L_xsf_ok
    s_sub_u32 s82, s82, 1
    s_cbranch_scc0 L_xsf
L_xsf_ok:
    ds_read_b128 v[128:131], v49 offset:0
    ds_read_b128 v[132:135], v49 offset:1024
    ds_read_b32 v136, v53 offset:2048
    ds_read_b128 v[140:143], v50 offset:2304
    ds_read_b128 v[144:147], v50 offset:3328
    ds_read_b32 v148, v54 offset:4352
    ds_read_b128 v[152:155], v51 offset:4608
    ds_read_b128 v[156:159], v51 offset:5632
    ds_read_b32 v160, v55 offset:6656
    s_waitcnt lgkmcnt(6)
    v_add_f32 v72, v72, v136
    v_pk_add_f32 v[64:65], v[64:65], v[128:129]
    v_pk_add_f32 v[66:67], v[66:67], v[130:131]
    v_pk_add_f32 v[68:69], v[68:69], v[132:133]
    v_pk_add_f32 v[70:71], v[70:71], v[134:135]
    s_waitcnt lgkmcnt(3)
    v_add_f32 v72, v72, v148
    v_pk_add_f32 v[64:65], v[64:65], v[140:141]
    v_pk_add_f32 v[66:67], v[66:67], v[142:143]
    v_pk_add_f32 v[68:69], v[68:69], v[144:145]
    v_pk_add_f32 v[70:71], v[70:71], v[146:147]
    s_waitcnt lgkmcnt(0)
    v_add_f32 v72, v72, v160
    v_pk_add_f32 v[64:65], v[64:65], v[152:153]
    v_pk_add_f32 v[66:67], v[66:67], v[154:155]
    v_pk_add_f32 v[68:69], v[68:69], v[156:157]
    v_pk_add_f32 v[70:71], v[70:71], v[158:159]
    v_rcp_f32 v72, v72
    v_mov_b32 v10, 1
    s_mov_b64 exec, 1
    ds_add_u32 v58, v10 offset:12
    s_mov_b64 exec, -1
    v_pk_mul_f32 v[64:65], v[64:65], v[72:73] op_sel_hi:[1,0]
    v_pk_mul_f32 v[66:67], v[66:67], v[72:73] op_sel_hi:[1,0]
    v_pk_mul_f32 v[68:69], v[68:69], v[72:73] op_sel_hi:[1,0]
    v_pk_mul_f32 v[70:71], v[70:71], v[72:73] op_sel_hi:[1,0]
    v_cvt_pk_bf16_f32 v76, v64, v65
    v_cvt_pk_bf16_f32 v77, v66, v67
    v_cvt_pk_bf16_f32 v78, v68, v69
    v_cvt_pk_bf16_f32 v79, v70, v71
    v_min_u32 v76, -2, v76
    v_min_u32 v77, -2, v77
    v_min_u32 v78, -2, v78
    v_min_u32 v79, -2, v79
    buffer_store_dwordx4 v[76:79], v245, s[68:71], s93 offen sc1
L_tail:
    s_cmp_ge_u32 s3, 4
    s_cbranch_scc1 L_end
    s_setprio 0
    s_mov_b32 s76, s36
    s_mov_b32 s77, s37
    s_mov_b32 s78, 2097152
    s_mov_b32 s79, 0x20000
    v_and_b32 v24, 7, v1
    v_lshlrev_b32 v24, 15, v24
    v_bfe_u32 v25, v1, 3, 1
    v_lshl_add_u32 v24, v25, 10, v24
    s_bfe_u32 s11, s84, 0x20002
    s_lshl_b32 s11, s11, 13
    s_lshr_b32 s8, s84, 4
    s_lshl_b32 s8, s8, 11
    s_add_u32 s11, s11, s8
    s_and_b32 s8, s84, 3
    s_lshl_b32 s8, s8, 7
    s_add_u32 s11, s11, s8
    s_add_u32 s11, s11, 14811136
    v_bfe_u32 v25, v1, 4, 1
    v_lshl_add_u32 v24, v25, 9, v24
    v_add_u32 v13, s11, v24
    s_lshl_b32 s10, s85, 2
    s_add_u32 s14, s10, s3
    s_lshl_b32 s10, s14, 14
    s_lshr_b32 s11, s84, 3
    s_lshl_b32 s11, s11, 7
    s_add_u32 s10, s10, s11
    s_add_u32 s10, s10, 14811136
    v_and_b32 v24, 15, v1
    v_lshl_add_u32 v14, v24, 10, s10
    s_lshl_b32 s9, s14, 6
    s_lshl_b32 s12, s3, 15
    v_lshrrev_b32 v26, 5, v1
    v_bfe_u32 v25, v1, 2, 2
    v_lshl_add_u32 v5, v26, 2, v25
    v_lshlrev_b32 v5, 6, v5
    v_bfe_u32 v25, v1, 4, 1
    v_lshl_add_u32 v5, v25, 5, v5
    v_and_b32 v24, 1, v1
    v_lshl_add_u32 v5, v24, 4, v5
    v_bfe_u32 v25, v1, 1, 1
    v_lshl_add_u32 v5, v25, 3, v5
    v_add_u32 v5, s12, v5
    v_add_u32 v7, 0x10000, v245
    v_add_u32 v8, s12, v245
    v_mov_b32 v4, 163776
    s_lshl_b32 s94, s84, 3
    s_add_u32 s94, s94, s3
    s_lshl_b32 s94, s94, 12
    s_add_u32 s94, s94, 12582912
    s_add_u32 s83, s94, 16384
    v_and_b32 v3, 31, v1
    v_lshlrev_b32 v9, 10, v3
    v_lshl_add_u32 v9, v26, 4, v9
    s_lshl_b32 s10, s84, 15
    s_add_u32 s10, s10, s9
    v_add_u32 v9, s10, v9
    v_bfe_u32 v15, v1, 3, 2
    v_lshlrev_b32 v15, 5, v15
    v_lshl_add_u32 v15, v24, 4, v15
    v_bfe_u32 v25, v1, 1, 2
    v_lshl_add_u32 v15, v25, 2, v15
    v_mul_u32_u24 v25, 33792, v26
    v_add_u32 v15, v25, v15
    s_mul_i32 s96, s14, 135168
    s_lshl_b32 s97, s84, 7
    s_add_u32 s96, s96, s97
    s_add_u32 s96, s96, 9437184
    v_lshlrev_b32 v3, 2, v3
    s_add_u32 s97, s97, 14680064
    s_setprio 0
    s_lshl_b32 s8, s2, 3
    s_add_u32 s8, s8, s3
    s_lshl_b32 s8, s8, 7
    s_add_u32 s8, s8, 14811136
    v_mov_b32 v12, s43
    v_mov_b32 v2, 0
    s_lshl_b64 exec, 1, 63
    buffer_store_dword v12, v2, s[68:71], s8 offen sc1
    s_mov_b64 exec, -1
    buffer_load_dword v11, v13, s[68:71], 0 offen sc1
    s_mov_b32 s82, 2097152
L_ws:
    ds_read_b32 v10, v4 offset:24
    s_waitcnt lgkmcnt(0)
    v_cmp_gt_u32 vcc, 4, v10
    s_cbranch_vccz L_ws_ok
    s_sub_u32 s82, s82, 1
    s_cbranch_scc0 L_ws
L_ws_ok:
    ds_read_b64_tr_b16 v[16:17], v5 offset:0
    ds_read_b64_tr_b16 v[18:19], v5 offset:512
    ds_read_b64_tr_b16 v[20:21], v5 offset:1024
    ds_read_b64_tr_b16 v[22:23], v5 offset:1536
    ds_read_b64_tr_b16 v[24:25], v5 offset:2048
    ds_read_b64_tr_b16 v[26:27], v5 offset:2560
    ds_read_b64_tr_b16 v[28:29], v5 offset:3072
    ds_read_b64_tr_b16 v[30:31], v5 offset:3584
    ds_read_b64_tr_b16 v[32:33], v5 offset:4096
    ds_read_b64_tr_b16 v[34:35], v5 offset:4608
    ds_read_b64_tr_b16 v[36:37], v5 offset:5120
    ds_read_b64_tr_b16 v[38:39], v5 offset:5632
    ds_read_b64_tr_b16 v[40:41], v5 offset:6144
    ds_read_b64_tr_b16 v[42:43], v5 offset:6656
    ds_read_b64_tr_b16 v[44:45], v5 offset:7168
    ds_read_b64_tr_b16 v[46:47], v5 offset:7680
    ds_read_b64_tr_b16 v[48:49], v5 offset:8192
    ds_read_b64_tr_b16 v[50:51], v5 offset:8704
    ds_read_b64_tr_b16 v[52:53], v5 offset:9216
    ds_read_b64_tr_b16 v[54:55], v5 offset:9728
    ds_read_b64_tr_b16 v[56:57], v5 offset:10240
    ds_read_b64_tr_b16 v[58:59], v5 offset:10752
    ds_read_b64_tr_b16 v[60:61], v5 offset:11264
    ds_read_b64_tr_b16 v[62:63], v5 offset:11776
    ds_read_b64_tr_b16 v[128:129], v5 offset:12288
    ds_read_b64_tr_b16 v[130:131], v5 offset:12800
    ds_read_b64_tr_b16 v[132:133], v5 offset:13312
    ds_read_b64_tr_b16 v[134:135], v5 offset:13824
    ds_read_b64_tr_b16 v[136:137], v5 offset:14336
    ds_read_b64_tr_b16 v[138:139], v5 offset:14848
    ds_read_b64_tr_b16 v[140:141], v5 offset:15360
    ds_read_b64_tr_b16 v[142:143], v5 offset:15872
    ds_read_b64_tr_b16 v[144:145], v5 offset:16384
    ds_read_b64_tr_b16 v[146:147], v5 offset:16896
    ds_read_b64_tr_b16 v[148:149], v5 offset:17408
    ds_read_b64_tr_b16 v[150:151], v5 offset:17920
    ds_read_b64_tr_b16 v[152:153], v5 offset:18432
    ds_read_b64_tr_b16 v[154:155], v5 offset:18944
    ds_read_b64_tr_b16 v[156:157], v5 offset:19456
    ds_read_b64_tr_b16 v[158:159], v5 offset:19968
    ds_read_b64_tr_b16 v[160:161], v5 offset:20480
    ds_read_b64_tr_b16 v[162:163], v5 offset:20992
    ds_read_b64_tr_b16 v[164:165], v5 offset:21504
    ds_read_b64_tr_b16 v[166:167], v5 offset:22016
    ds_read_b64_tr_b16 v[168:169], v5 offset:22528
    ds_read_b64_tr_b16 v[170:171], v5 offset:23040
    ds_read_b64_tr_b16 v[172:173], v5 offset:23552
    ds_read_b64_tr_b16 v[174:175], v5 offset:24064
    ds_read_b64_tr_b16 v[176:177], v5 offset:24576
    ds_read_b64_tr_b16 v[178:179], v5 offset:25088
    ds_read_b64_tr_b16 v[180:181], v5 offset:25600
    ds_read_b64_tr_b16 v[182:183], v5 offset:26112
    ds_read_b64_tr_b16 v[184:185], v5 offset:26624
    ds_read_b64_tr_b16 v[186:187], v5 offset:27136
    ds_read_b64_tr_b16 v[188:189], v5 offset:27648
    ds_read_b64_tr_b16 v[190:191], v5 offset:28160
    ds_read_b64_tr_b16 v[192:193], v5 offset:28672
    ds_read_b64_tr_b16 v[194:195], v5 offset:29184
    ds_read_b64_tr_b16 v[196:197], v5 offset:29696
    ds_read_b64_tr_b16 v[198:199], v5 offset:30208
    ds_read_b64_tr_b16 v[200:201], v5 offset:30720
    ds_read_b64_tr_b16 v[202:203], v5 offset:31232
    ds_read_b64_tr_b16 v[204:205], v5 offset:31744
    ds_read_b64_tr_b16 v[206:207], v5 offset:32256
    s_mov_b32 s82, 262144
    s_waitcnt vmcnt(0)
    s_branch L_pollfa_chk
L_pollfa:
    buffer_load_dword v11, v13, s[68:71], 0 offen sc1
    s_waitcnt vmcnt(0)
L_pollfa_chk:
    v_cmp_ne_u32 vcc, s43, v11
    s_cbranch_vccz L_pollfa_ok
    s_sub_u32 s82, s82, 1
    s_cbranch_scc0 L_pollfa
L_pollfa_ok:
    buffer_load_dwordx4 v[208:211], v245, s[68:71], s94 offen offset:0 sc1
    buffer_load_dwordx4 v[212:215], v245, s[68:71], s94 offen offset:1024 sc1
    buffer_load_dwordx4 v[216:219], v245, s[68:71], s94 offen offset:2048 sc1
    buffer_load_dwordx4 v[220:223], v245, s[68:71], s94 offen offset:3072 sc1
    buffer_load_dword v6, v14, s[68:71], 0 offen sc1
    s_waitcnt lgkmcnt(0)
    s_mov_b32 s82, 262144
    s_branch L_pollo0_chk
L_pollo0:
    buffer_load_dwordx4 v[208:211], v245, s[68:71], s94 offen offset:0 sc1
    buffer_load_dwordx4 v[212:215], v245, s[68:71], s94 offen offset:1024 sc1
    buffer_load_dwordx4 v[216:219], v245, s[68:71], s94 offen offset:2048 sc1
    buffer_load_dwordx4 v[220:223], v245, s[68:71], s94 offen offset:3072 sc1
L_pollo0_chk:
    s_waitcnt vmcnt(0)
    v_max3_u32 v12, v208, v209, v210
    v_max3_u32 v12, v12, v211, v212
    v_max3_u32 v12, v12, v213, v214
    v_max3_u32 v12, v12, v215, v216
    v_max3_u32 v12, v12, v217, v218
    v_max3_u32 v12, v12, v219, v220
    v_max3_u32 v12, v12, v221, v222
    v_max_u32 v12, v12, v223
    v_cmp_eq_u32 vcc, -1, v12
    s_cbranch_vccz L_pollo0_ok
    s_sub_u32 s82, s82, 1
    s_cbranch_scc0 L_pollo0
L_pollo0_ok:
    ds_write_b128 v8, v[208:211] offset:0
    ds_write_b128 v8, v[212:215] offset:1024
    ds_write_b128 v8, v[216:219] offset:2048
    ds_write_b128 v8, v[220:223] offset:3072
    s_waitcnt lgkmcnt(0)
    v_mov_b32 v10, 1
    s_mov_b64 exec, 1
    ds_add_u32 v4, v10 offset:20
    s_mov_b64 exec, -1
    s_mov_b32 s82, 262144
    s_branch L_pollfb_chk
L_pollfb:
    buffer_load_dword v6, v14, s[68:71], 0 offen sc1
    s_waitcnt vmcnt(0)
L_pollfb_chk:
    v_cmp_ne_u32 vcc, s43, v6
    s_cbranch_vccz L_pollfb_ok
    s_sub_u32 s82, s82, 1
    s_cbranch_scc0 L_pollfb
L_pollfb_ok:
    buffer_load_dwordx4 v[224:227], v9, s[44:47], 0 offen offset:0
    buffer_load_dwordx4 v[228:231], v9, s[44:47], 0 offen offset:32
    buffer_load_dword v232, v15, s[68:71], s96 offen sc1
    s_add_u32 s96, s96, 8448
    buffer_load_dword v233, v15, s[68:71], s96 offen sc1
    s_add_u32 s96, s96, 8448
    buffer_load_dword v234, v15, s[68:71], s96 offen sc1
    s_add_u32 s96, s96, 8448
    buffer_load_dword v235, v15, s[68:71], s96 offen sc1
    s_add_u32 s96, s96, 42240
    buffer_load_dword v236, v15, s[68:71], s96 offen sc1
    s_add_u32 s96, s96, 8448
    buffer_load_dword v237, v15, s[68:71], s96 offen sc1
    s_add_u32 s96, s96, 8448
    buffer_load_dword v238, v15, s[68:71], s96 offen sc1
    s_add_u32 s96, s96, 8448
    buffer_load_dword v239, v15, s[68:71], s96 offen sc1
    buffer_load_dword v240, v3, s[68:71], s97 offen sc1
    s_mov_b32 s82, 2097152
L_es:
    ds_read_b32 v10, v4 offset:20
    s_waitcnt lgkmcnt(0)
    v_cmp_gt_u32 vcc, 4, v10
    s_cbranch_vccz L_es_ok
    s_sub_u32 s82, s82, 1
    s_cbranch_scc0 L_es
L_es_ok:
    ds_read_b128 v[80:83], v245 offset:0
    ds_read_b128 v[84:87], v245 offset:1024
    ds_read_b128 v[88:91], v245 offset:2048
    ds_read_b128 v[92:95], v245 offset:3072
    ds_read_b128 v[96:99], v245 offset:32768
    ds_read_b128 v[100:103], v245 offset:33792
    ds_read_b128 v[104:107], v245 offset:34816
    ds_read_b128 v[108:111], v245 offset:35840
    s_waitcnt lgkmcnt(7)
    v_mfma_f32_32x32x16_bf16 v[64:79], v[16:19], v[80:83], 0
    ds_read_b128 v[80:83], v7 offset:0
    s_waitcnt lgkmcnt(7)
    v_mfma_f32_32x32x16_bf16 v[64:79], v[24:27], v[84:87], v[64:79]
    ds_read_b128 v[84:87], v7 offset:1024
    s_waitcnt lgkmcnt(7)
    v_mfma_f32_32x32x16_bf16 v[64:79], v[32:35], v[88:91], v[64:79]
    ds_read_b128 v[88:91], v7 offset:2048
    s_waitcnt lgkmcnt(7)
    v_mfma_f32_32x32x16_bf16 v[64:79], v[40:43], v[92:95], v[64:79]
    ds_read_b128 v[92:95], v7 offset:3072
    s_waitcnt lgkmcnt(7)
    v_mfma_f32_32x32x16_bf16 v[64:79], v[48:51], v[96:99], v[64:79]
    ds_read_b128 v[96:99], v7 offset:32768
    s_waitcnt lgkmcnt(7)
    v_mfma_f32_32x32x16_bf16 v[64:79], v[56:59], v[100:103], v[64:79]
    ds_read_b128 v[100:103], v7 offset:33792
    s_waitcnt lgkmcnt(7)
    v_mfma_f32_32x32x16_bf16 v[64:79], v[128:131], v[104:107], v[64:79]
    ds_read_b128 v[104:107], v7 offset:34816
    s_waitcnt lgkmcnt(7)
    v_mfma_f32_32x32x16_bf16 v[64:79], v[136:139], v[108:111], v[64:79]
    ds_read_b128 v[108:111], v7 offset:35840
    s_waitcnt lgkmcnt(7)
    v_mfma_f32_32x32x16_bf16 v[64:79], v[144:147], v[80:83], v[64:79]
    s_waitcnt lgkmcnt(6)
    v_mfma_f32_32x32x16_bf16 v[64:79], v[152:155], v[84:87], v[64:79]
    s_waitcnt lgkmcnt(5)
    v_mfma_f32_32x32x16_bf16 v[64:79], v[160:163], v[88:91], v[64:79]
    s_waitcnt lgkmcnt(4)
    v_mfma_f32_32x32x16_bf16 v[64:79], v[168:171], v[92:95], v[64:79]
    s_waitcnt lgkmcnt(3)
    v_mfma_f32_32x32x16_bf16 v[64:79], v[176:179], v[96:99], v[64:79]
    s_waitcnt lgkmcnt(2)
    v_mfma_f32_32x32x16_bf16 v[64:79], v[184:187], v[100:103], v[64:79]
    s_waitcnt lgkmcnt(1)
    v_mfma_f32_32x32x16_bf16 v[64:79], v[192:195], v[104:107], v[64:79]
    s_waitcnt lgkmcnt(0)
    v_mfma_f32_32x32x16_bf16 v[64:79], v[200:203], v[108:111], v[64:79]
    s_barrier
    buffer_load_dwordx4 v[208:211], v245, s[68:71], s83 offen offset:0 sc1
    buffer_load_dwordx4 v[212:215], v245, s[68:71], s83 offen offset:1024 sc1
    buffer_load_dwordx4 v[216:219], v245, s[68:71], s83 offen offset:2048 sc1
    buffer_load_dwordx4 v[220:223], v245, s[68:71], s83 offen offset:3072 sc1
    s_waitcnt vmcnt(4)
    v_sub_f32 v10, 1.0, v240
    v_lshlrev_b32 v112, 16, v224
    v_and_b32 v113, 0xffff0000, v224
    v_lshlrev_b32 v12, 16, v232
    v_and_b32 v13, 0xffff0000, v232
    v_pk_mul_f32 v[112:113], v[112:113], v[12:13]
    v_pk_mul_f32 v[112:113], v[112:113], v[10:11] op_sel_hi:[1,0]
    v_lshlrev_b32 v114, 16, v225
    v_and_b32 v115, 0xffff0000, v225
    v_lshlrev_b32 v12, 16, v233
    v_and_b32 v13, 0xffff0000, v233
    v_pk_mul_f32 v[114:115], v[114:115], v[12:13]
    v_pk_mul_f32 v[114:115], v[114:115], v[10:11] op_sel_hi:[1,0]
    v_lshlrev_b32 v116, 16, v226
    v_and_b32 v117, 0xffff0000, v226
    v_lshlrev_b32 v12, 16, v234
    v_and_b32 v13, 0xffff0000, v234
    v_pk_mul_f32 v[116:117], v[116:117], v[12:13]
    v_pk_mul_f32 v[116:117], v[116:117], v[10:11] op_sel_hi:[1,0]
    v_lshlrev_b32 v118, 16, v227
    v_and_b32 v119, 0xffff0000, v227
    v_lshlrev_b32 v12, 16, v235
    v_and_b32 v13, 0xffff0000, v235
    v_pk_mul_f32 v[118:119], v[118:119], v[12:13]
    v_pk_mul_f32 v[118:119], v[118:119], v[10:11] op_sel_hi:[1,0]
    v_lshlrev_b32 v120, 16, v228
    v_and_b32 v121, 0xffff0000, v228
    v_lshlrev_b32 v12, 16, v236
    v_and_b32 v13, 0xffff0000, v236
    v_pk_mul_f32 v[120:121], v[120:121], v[12:13]
    v_pk_mul_f32 v[120:121], v[120:121], v[10:11] op_sel_hi:[1,0]
    v_lshlrev_b32 v122, 16, v229
    v_and_b32 v123, 0xffff0000, v229
    v_lshlrev_b32 v12, 16, v237
    v_and_b32 v13, 0xffff0000, v237
    v_pk_mul_f32 v[122:123], v[122:123], v[12:13]
    v_pk_mul_f32 v[122:123], v[122:123], v[10:11] op_sel_hi:[1,0]
    v_lshlrev_b32 v124, 16, v230
    v_and_b32 v125, 0xffff0000, v230
    v_lshlrev_b32 v12, 16, v238
    v_and_b32 v13, 0xffff0000, v238
    v_pk_mul_f32 v[124:125], v[124:125], v[12:13]
    v_pk_mul_f32 v[124:125], v[124:125], v[10:11] op_sel_hi:[1,0]
    v_lshlrev_b32 v126, 16, v231
    v_and_b32 v127, 0xffff0000, v231
    v_lshlrev_b32 v12, 16, v239
    v_and_b32 v13, 0xffff0000, v239
    v_pk_mul_f32 v[126:127], v[126:127], v[12:13]
    v_pk_mul_f32 v[126:127], v[126:127], v[10:11] op_sel_hi:[1,0]
    s_mov_b32 s82, 262144
    s_branch L_pollo1_chk
L_pollo1:
    buffer_load_dwordx4 v[208:211], v245, s[68:71], s83 offen offset:0 sc1
    buffer_load_dwordx4 v[212:215], v245, s[68:71], s83 offen offset:1024 sc1
    buffer_load_dwordx4 v[216:219], v245, s[68:71], s83 offen offset:2048 sc1
    buffer_load_dwordx4 v[220:223], v245, s[68:71], s83 offen offset:3072 sc1
L_pollo1_chk:
    s_waitcnt vmcnt(0)
    v_max3_u32 v12, v208, v209, v210
    v_max3_u32 v12, v12, v211, v212
    v_max3_u32 v12, v12, v213, v214
    v_max3_u32 v12, v12, v215, v216
    v_max3_u32 v12, v12, v217, v218
    v_max3_u32 v12, v12, v219, v220
    v_max3_u32 v12, v12, v221, v222
    v_max_u32 v12, v12, v223
    v_cmp_eq_u32 vcc, -1, v12
    s_cbranch_vccz L_pollo1_ok
    s_sub_u32 s82, s82, 1
    s_cbranch_scc0 L_pollo1
L_pollo1_ok:
    ds_write_b128 v8, v[208:211] offset:4096
    ds_write_b128 v8, v[212:215] offset:5120
    ds_write_b128 v8, v[216:219] offset:6144
    ds_write_b128 v8, v[220:223] offset:7168
    s_waitcnt lgkmcnt(0)
    s_barrier
    ds_read_b128 v[80:83], v245 offset:4096
    ds_read_b128 v[84:87], v245 offset:5120
    ds_read_b128 v[88:91], v245 offset:6144
    ds_read_b128 v[92:95], v245 offset:7168
    ds_read_b128 v[96:99], v245 offset:36864
    ds_read_b128 v[100:103], v245 offset:37888
    ds_read_b128 v[104:107], v245 offset:38912
    ds_read_b128 v[108:111], v245 offset:39936
    s_waitcnt lgkmcnt(7)
    v_mfma_f32_32x32x16_bf16 v[64:79], v[20:23], v[80:83], v[64:79]
    ds_read_b128 v[80:83], v7 offset:4096
    s_waitcnt lgkmcnt(7)
    v_mfma_f32_32x32x16_bf16 v[64:79], v[28:31], v[84:87], v[64:79]
    ds_read_b128 v[84:87], v7 offset:5120
    s_waitcnt lgkmcnt(7)
    v_mfma_f32_32x32x16_bf16 v[64:79], v[36:39], v[88:91], v[64:79]
    ds_read_b128 v[88:91], v7 offset:6144
    s_waitcnt lgkmcnt(7)
    v_mfma_f32_32x32x16_bf16 v[64:79], v[44:47], v[92:95], v[64:79]
    ds_read_b128 v[92:95], v7 offset:7168
    s_waitcnt lgkmcnt(7)
    v_mfma_f32_32x32x16_bf16 v[64:79], v[52:55], v[96:99], v[64:79]
    ds_read_b128 v[96:99], v7 offset:36864
    s_waitcnt lgkmcnt(7)
    v_mfma_f32_32x32x16_bf16 v[64:79], v[60:63], v[100:103], v[64:79]
    ds_read_b128 v[100:103], v7 offset:37888
    s_waitcnt lgkmcnt(7)
    v_mfma_f32_32x32x16_bf16 v[64:79], v[132:135], v[104:107], v[64:79]
    ds_read_b128 v[104:107], v7 offset:38912
    s_waitcnt lgkmcnt(7)
    v_mfma_f32_32x32x16_bf16 v[64:79], v[140:143], v[108:111], v[64:79]
    ds_read_b128 v[108:111], v7 offset:39936
    s_waitcnt lgkmcnt(7)
    v_mfma_f32_32x32x16_bf16 v[64:79], v[148:151], v[80:83], v[64:79]
    s_waitcnt lgkmcnt(6)
    v_mfma_f32_32x32x16_bf16 v[64:79], v[156:159], v[84:87], v[64:79]
    s_waitcnt lgkmcnt(5)
    v_mfma_f32_32x32x16_bf16 v[64:79], v[164:167], v[88:91], v[64:79]
    s_waitcnt lgkmcnt(4)
    v_mfma_f32_32x32x16_bf16 v[64:79], v[172:175], v[92:95], v[64:79]
    s_waitcnt lgkmcnt(3)
    v_mfma_f32_32x32x16_bf16 v[64:79], v[180:183], v[96:99], v[64:79]
    s_waitcnt lgkmcnt(2)
    v_mfma_f32_32x32x16_bf16 v[64:79], v[188:191], v[100:103], v[64:79]
    s_waitcnt lgkmcnt(1)
    v_mfma_f32_32x32x16_bf16 v[64:79], v[196:199], v[104:107], v[64:79]
    s_waitcnt lgkmcnt(0)
    v_mfma_f32_32x32x16_bf16 v[64:79], v[204:207], v[108:111], v[64:79]
    s_nop 11
    v_pk_fma_f32 v[64:65], v[64:65], v[240:241], v[112:113] op_sel_hi:[1,0,1]
    v_pk_fma_f32 v[66:67], v[66:67], v[240:241], v[114:115] op_sel_hi:[1,0,1]
    v_pk_fma_f32 v[68:69], v[68:69], v[240:241], v[116:117] op_sel_hi:[1,0,1]
    v_pk_fma_f32 v[70:71], v[70:71], v[240:241], v[118:119] op_sel_hi:[1,0,1]
    v_pk_fma_f32 v[72:73], v[72:73], v[240:241], v[120:121] op_sel_hi:[1,0,1]
    v_pk_fma_f32 v[74:75], v[74:75], v[240:241], v[122:123] op_sel_hi:[1,0,1]
    v_pk_fma_f32 v[76:77], v[76:77], v[240:241], v[124:125] op_sel_hi:[1,0,1]
    v_pk_fma_f32 v[78:79], v[78:79], v[240:241], v[126:127] op_sel_hi:[1,0,1]
    v_cvt_pk_bf16_f32 v80, v64, v65
    v_cvt_pk_bf16_f32 v81, v66, v67
    v_cvt_pk_bf16_f32 v82, v68, v69
    v_cvt_pk_bf16_f32 v83, v70, v71
    v_cvt_pk_bf16_f32 v84, v72, v73
    v_cvt_pk_bf16_f32 v85, v74, v75
    v_cvt_pk_bf16_f32 v86, v76, v77
    v_cvt_pk_bf16_f32 v87, v78, v79
    buffer_store_dwordx4 v[80:83], v9, s[76:79], 0 offen offset:0
    buffer_store_dwordx4 v[84:87], v9, s[76:79], 0 offen offset:32
    s_or_b32 s8, s2, s3
    s_cbranch_scc1 L_nogen
    v_mov_b32 v12, s43
    v_mov_b32 v13, 15073280
    s_mov_b64 exec, 1
    buffer_store_dword v12, v13, s[68:71], 0 offen sc0 sc1
    s_mov_b64 exec, -1
L_nogen:
L_end:
    s_endpgm
L_hook:
L_wof:
    s_mov_b32 m0, s95
    s_add_u32 s95, s95, 4096
    buffer_load_dwordx4 v60, s[48:51], s92 offen offset:0 lds
    buffer_load_dwordx4 v61, s[48:51], s92 offen offset:1024 lds
    buffer_load_dwordx4 v62, s[48:51], s92 offen offset:2048 lds
    buffer_load_dwordx4 v63, s[48:51], s92 offen offset:3072 lds
    s_add_u32 s92, s92, 65536
    s_cmp_lt_u32 s92, 524288
    s_waitcnt vmcnt(0)
    s_cbranch_scc1 L_wof
    v_mov_b32 v10, 1
    s_mov_b64 exec, 1
    ds_add_u32 v58, v10 offset:20
    s_mov_b64 exec, -1
    s_lshl_b32 s8, s2, 3
    s_add_u32 s8, s8, s3
    s_lshl_b32 s8, s8, 7
    s_add_u32 s8, s8, 14811136
    v_mov_b32 v12, s43
    v_mov_b32 v2, 0
    s_lshl_b64 exec, 1, 63
    buffer_store_dword v12, v2, s[68:71], s8 offen sc1
    s_mov_b64 exec, -1
    s_branch L_back
L_slow:
    v_mov_b32 v44, 0xff7fffff
    v_mov_b32 v45, 0xff7fffff
    v_mov_b32 v46, 0xff7fffff
    v_mov_b32 v47, 0xff7fffff
    s_waitcnt vmcnt(0)
    v_mov_b32 v32, 0
    v_mov_b32 v33, 0
    v_mov_b32 v34, 0
    v_mov_b32 v35, 0
    s_nop 1
    v_mfma_f32_32x32x16_bf16 v[64:79], v[32:35], v[32:35], 0
    v_mfma_f32_32x32x16_bf16 v[80:95], v[32:35], v[32:35], 0
    v_mfma_f32_32x32x16_bf16 v[96:111], v[32:35], v[32:35], 0
    v_mfma_f32_32x32x16_bf16 v[112:127], v[32:35], v[32:35], 0
    s_cmp_lt_u32 s3, 4
    s_cbranch_scc1 L_nostage
L_wos:
    s_mov_b32 m0, s95
    s_add_u32 s95, s95, 4096
    buffer_load_dwordx4 v60, s[48:51], s92 offen offset:0 lds
    buffer_load_dwordx4 v61, s[48:51], s92 offen offset:1024 lds
    buffer_load_dwordx4 v62, s[48:51], s92 offen offset:2048 lds
    buffer_load_dwordx4 v63, s[48:51], s92 offen offset:3072 lds
    s_add_u32 s92, s92, 65536
    s_cmp_lt_u32 s92, 524288
    s_waitcnt vmcnt(0)
    s_cbranch_scc1 L_wos
    v_mov_b32 v10, 1
    s_mov_b64 exec, 1
    ds_add_u32 v58, v10 offset:20
    s_mov_b64 exec, -1
    s_lshl_b32 s8, s2, 3
    s_add_u32 s8, s8, s3
    s_lshl_b32 s8, s8, 7
    s_add_u32 s8, s8, 14811136
    v_mov_b32 v12, s43
    v_mov_b32 v2, 0
    s_lshl_b64 exec, 1, 63
    buffer_store_dword v12, v2, s[68:71], s8 offen sc1
    s_mov_b64 exec, -1
L_nostage:
    s_mov_b32 s89, 4294934528
    s_mov_b32 s11, 0
L_slowloop:
    s_add_u32 s89, s89, 32768
    s_xor_b32 s38, s88, s89
    global_load_dwordx4 v[208:211], v245, s[38:39] sc1
    global_load_dwordx4 v[212:215], v246, s[38:39] offset:1024 sc1
    global_load_dwordx4 v[216:219], v247, s[38:39] offset:1536 sc1
    s_waitcnt vmcnt(0)
    v_mfma_f32_32x32x16_bf16 v[128:143], v[208:211], v[192:195], 0
    v_mfma_f32_32x32x16_bf16 v[144:159], v[208:211], v[196:199], 0
    v_mfma_f32_32x32x16_bf16 v[160:175], v[208:211], v[200:203], 0
    v_mfma_f32_32x32x16_bf16 v[176:191], v[208:211], v[204:207], 0
    s_nop 8
    v_max3_f32 v10, v128, v129, v44
    v_max3_f32 v10, v130, v131, v10
    v_max3_f32 v10, v132, v133, v10
    v_max3_f32 v10, v134, v135, v10
    v_max3_f32 v10, v136, v137, v10
    v_max3_f32 v10, v138, v139, v10
    v_max3_f32 v10, v140, v141, v10
    v_max3_f32 v10, v142, v143, v10
    v_mov_b32 v11, v10
    s_nop 1
    v_permlane32_swap_b32 v10, v11
    v_max_f32 v10, v10, v11
    v_sub_f32 v11, v44, v10
    v_exp_f32 v11, v11
    v_mov_b32 v44, v10
    v_sub_f32 v128, v128, v10
    v_exp_f32 v128, v128
    v_sub_f32 v129, v129, v10
    v_exp_f32 v129, v129
    v_sub_f32 v130, v130, v10
    v_exp_f32 v130, v130
    v_sub_f32 v131, v131, v10
    v_exp_f32 v131, v131
    v_sub_f32 v132, v132, v10
    v_exp_f32 v132, v132
    v_sub_f32 v133, v133, v10
    v_exp_f32 v133, v133
    v_sub_f32 v134, v134, v10
    v_exp_f32 v134, v134
    v_sub_f32 v135, v135, v10
    v_exp_f32 v135, v135
    v_sub_f32 v136, v136, v10
    v_exp_f32 v136, v136
    v_sub_f32 v137, v137, v10
    v_exp_f32 v137, v137
    v_sub_f32 v138, v138, v10
    v_exp_f32 v138, v138
    v_sub_f32 v139, v139, v10
    v_exp_f32 v139, v139
    v_sub_f32 v140, v140, v10
    v_exp_f32 v140, v140
    v_sub_f32 v141, v141, v10
    v_exp_f32 v141, v141
    v_sub_f32 v142, v142, v10
    v_exp_f32 v142, v142
    v_sub_f32 v143, v143, v10
    v_exp_f32 v143, v143
    v_mul_f32 v64, v64, v11
    v_mul_f32 v65, v65, v11
    v_mul_f32 v66, v66, v11
    v_mul_f32 v67, v67, v11
    v_mul_f32 v68, v68, v11
    v_mul_f32 v69, v69, v11
    v_mul_f32 v70, v70, v11
    v_mul_f32 v71, v71, v11
    v_mul_f32 v72, v72, v11
    v_mul_f32 v73, v73, v11
    v_mul_f32 v74, v74, v11
    v_mul_f32 v75, v75, v11
    v_mul_f32 v76, v76, v11
    v_mul_f32 v77, v77, v11
    v_mul_f32 v78, v78, v11
    v_mul_f32 v79, v79, v11
    s_nop 1
    v_smfmac_f32_32x32x32_bf16 v[64:79], v[212:215], v[128:135], v244
    v_smfmac_f32_32x32x32_bf16 v[64:79], v[216:219], v[136:143], v244
    v_max3_f32 v10, v144, v145, v45
    v_max3_f32 v10, v146, v147, v10
    v_max3_f32 v10, v148, v149, v10
    v_max3_f32 v10, v150, v151, v10
    v_max3_f32 v10, v152, v153, v10
    v_max3_f32 v10, v154, v155, v10
    v_max3_f32 v10, v156, v157, v10
    v_max3_f32 v10, v158, v159, v10
    v_mov_b32 v11, v10
    s_nop 1
    v_permlane32_swap_b32 v10, v11
    v_max_f32 v10, v10, v11
    v_sub_f32 v11, v45, v10
    v_exp_f32 v11, v11
    v_mov_b32 v45, v10
    v_sub_f32 v144, v144, v10
    v_exp_f32 v144, v144
    v_sub_f32 v145, v145, v10
    v_exp_f32 v145, v145
    v_sub_f32 v146, v146, v10
    v_exp_f32 v146, v146
    v_sub_f32 v147, v147, v10
    v_exp_f32 v147, v147
    v_sub_f32 v148, v148, v10
    v_exp_f32 v148, v148
    v_sub_f32 v149, v149, v10
    v_exp_f32 v149, v149
    v_sub_f32 v150, v150, v10
    v_exp_f32 v150, v150
    v_sub_f32 v151, v151, v10
    v_exp_f32 v151, v151
    v_sub_f32 v152, v152, v10
    v_exp_f32 v152, v152
    v_sub_f32 v153, v153, v10
    v_exp_f32 v153, v153
    v_sub_f32 v154, v154, v10
    v_exp_f32 v154, v154
    v_sub_f32 v155, v155, v10
    v_exp_f32 v155, v155
    v_sub_f32 v156, v156, v10
    v_exp_f32 v156, v156
    v_sub_f32 v157, v157, v10
    v_exp_f32 v157, v157
    v_sub_f32 v158, v158, v10
    v_exp_f32 v158, v158
    v_sub_f32 v159, v159, v10
    v_exp_f32 v159, v159
    v_mul_f32 v80, v80, v11
    v_mul_f32 v81, v81, v11
    v_mul_f32 v82, v82, v11
    v_mul_f32 v83, v83, v11
    v_mul_f32 v84, v84, v11
    v_mul_f32 v85, v85, v11
    v_mul_f32 v86, v86, v11
    v_mul_f32 v87, v87, v11
    v_mul_f32 v88, v88, v11
    v_mul_f32 v89, v89, v11
    v_mul_f32 v90, v90, v11
    v_mul_f32 v91, v91, v11
    v_mul_f32 v92, v92, v11
    v_mul_f32 v93, v93, v11
    v_mul_f32 v94, v94, v11
    v_mul_f32 v95, v95, v11
    s_nop 1
    v_smfmac_f32_32x32x32_bf16 v[80:95], v[212:215], v[144:151], v244
    v_smfmac_f32_32x32x32_bf16 v[80:95], v[216:219], v[152:159], v244
    v_max3_f32 v10, v160, v161, v46
    v_max3_f32 v10, v162, v163, v10
    v_max3_f32 v10, v164, v165, v10
    v_max3_f32 v10, v166, v167, v10
    v_max3_f32 v10, v168, v169, v10
    v_max3_f32 v10, v170, v171, v10
    v_max3_f32 v10, v172, v173, v10
    v_max3_f32 v10, v174, v175, v10
    v_mov_b32 v11, v10
    s_nop 1
    v_permlane32_swap_b32 v10, v11
    v_max_f32 v10, v10, v11
    v_sub_f32 v11, v46, v10
    v_exp_f32 v11, v11
    v_mov_b32 v46, v10
    v_sub_f32 v160, v160, v10
    v_exp_f32 v160, v160
    v_sub_f32 v161, v161, v10
    v_exp_f32 v161, v161
    v_sub_f32 v162, v162, v10
    v_exp_f32 v162, v162
    v_sub_f32 v163, v163, v10
    v_exp_f32 v163, v163
    v_sub_f32 v164, v164, v10
    v_exp_f32 v164, v164
    v_sub_f32 v165, v165, v10
    v_exp_f32 v165, v165
    v_sub_f32 v166, v166, v10
    v_exp_f32 v166, v166
    v_sub_f32 v167, v167, v10
    v_exp_f32 v167, v167
    v_sub_f32 v168, v168, v10
    v_exp_f32 v168, v168
    v_sub_f32 v169, v169, v10
    v_exp_f32 v169, v169
    v_sub_f32 v170, v170, v10
    v_exp_f32 v170, v170
    v_sub_f32 v171, v171, v10
    v_exp_f32 v171, v171
    v_sub_f32 v172, v172, v10
    v_exp_f32 v172, v172
    v_sub_f32 v173, v173, v10
    v_exp_f32 v173, v173
    v_sub_f32 v174, v174, v10
    v_exp_f32 v174, v174
    v_sub_f32 v175, v175, v10
    v_exp_f32 v175, v175
    v_mul_f32 v96, v96, v11
    v_mul_f32 v97, v97, v11
    v_mul_f32 v98, v98, v11
    v_mul_f32 v99, v99, v11
    v_mul_f32 v100, v100, v11
    v_mul_f32 v101, v101, v11
    v_mul_f32 v102, v102, v11
    v_mul_f32 v103, v103, v11
    v_mul_f32 v104, v104, v11
    v_mul_f32 v105, v105, v11
    v_mul_f32 v106, v106, v11
    v_mul_f32 v107, v107, v11
    v_mul_f32 v108, v108, v11
    v_mul_f32 v109, v109, v11
    v_mul_f32 v110, v110, v11
    v_mul_f32 v111, v111, v11
    s_nop 1
    v_smfmac_f32_32x32x32_bf16 v[96:111], v[212:215], v[160:167], v244
    v_smfmac_f32_32x32x32_bf16 v[96:111], v[216:219], v[168:175], v244
    v_max3_f32 v10, v176, v177, v47
    v_max3_f32 v10, v178, v179, v10
    v_max3_f32 v10, v180, v181, v10
    v_max3_f32 v10, v182, v183, v10
    v_max3_f32 v10, v184, v185, v10
    v_max3_f32 v10, v186, v187, v10
    v_max3_f32 v10, v188, v189, v10
    v_max3_f32 v10, v190, v191, v10
    v_mov_b32 v11, v10
    s_nop 1
    v_permlane32_swap_b32 v10, v11
    v_max_f32 v10, v10, v11
    v_sub_f32 v11, v47, v10
    v_exp_f32 v11, v11
    v_mov_b32 v47, v10
    v_sub_f32 v176, v176, v10
    v_exp_f32 v176, v176
    v_sub_f32 v177, v177, v10
    v_exp_f32 v177, v177
    v_sub_f32 v178, v178, v10
    v_exp_f32 v178, v178
    v_sub_f32 v179, v179, v10
    v_exp_f32 v179, v179
    v_sub_f32 v180, v180, v10
    v_exp_f32 v180, v180
    v_sub_f32 v181, v181, v10
    v_exp_f32 v181, v181
    v_sub_f32 v182, v182, v10
    v_exp_f32 v182, v182
    v_sub_f32 v183, v183, v10
    v_exp_f32 v183, v183
    v_sub_f32 v184, v184, v10
    v_exp_f32 v184, v184
    v_sub_f32 v185, v185, v10
    v_exp_f32 v185, v185
    v_sub_f32 v186, v186, v10
    v_exp_f32 v186, v186
    v_sub_f32 v187, v187, v10
    v_exp_f32 v187, v187
    v_sub_f32 v188, v188, v10
    v_exp_f32 v188, v188
    v_sub_f32 v189, v189, v10
    v_exp_f32 v189, v189
    v_sub_f32 v190, v190, v10
    v_exp_f32 v190, v190
    v_sub_f32 v191, v191, v10
    v_exp_f32 v191, v191
    v_mul_f32 v112, v112, v11
    v_mul_f32 v113, v113, v11
    v_mul_f32 v114, v114, v11
    v_mul_f32 v115, v115, v11
    v_mul_f32 v116, v116, v11
    v_mul_f32 v117, v117, v11
    v_mul_f32 v118, v118, v11
    v_mul_f32 v119, v119, v11
    v_mul_f32 v120, v120, v11
    v_mul_f32 v121, v121, v11
    v_mul_f32 v122, v122, v11
    v_mul_f32 v123, v123, v11
    v_mul_f32 v124, v124, v11
    v_mul_f32 v125, v125, v11
    v_mul_f32 v126, v126, v11
    v_mul_f32 v127, v127, v11
    s_nop 1
    v_smfmac_f32_32x32x32_bf16 v[112:127], v[212:215], v[176:183], v244
    v_smfmac_f32_32x32x32_bf16 v[112:127], v[216:219], v[184:191], v244
    s_add_u32 s11, s11, 1
    s_cmp_lt_u32 s11, 16
    s_nop 7
    s_nop 7
    s_cbranch_scc1 L_slowloop
    s_cmp_ge_u32 s3, 4
    s_cbranch_scc1 L_xfs_go
    s_nop 3
    s_branch L_xfs_ok
L_xfs_go:
    s_mov_b32 s82, 2097152
L_xfs:
    ds_read_b32 v10, v58 offset:8
    s_waitcnt lgkmcnt(0)
    v_cmp_gt_u32 vcc, 4, v10
    s_cbranch_vccz L_xfs_ok
    s_sub_u32 s82, s82, 1
    s_cbranch_scc0 L_xfs
L_xfs_ok:
    ds_write_b128 v56, v[80:83] offset:0
    ds_write_b128 v56, v[84:87] offset:1024
    ds_write_b32 v57, v88 offset:2048
    ds_write_b128 v56, v[96:99] offset:2304
    ds_write_b128 v56, v[100:103] offset:3328
    ds_write_b32 v57, v104 offset:4352
    ds_write_b128 v56, v[112:115] offset:4608
    ds_write_b128 v56, v[116:119] offset:5632
    ds_write_b32 v57, v120 offset:6656
    s_mul_i32 s8, s3, 384
    s_add_u32 s8, s8, 158720
    v_and_b32 v63, 31, v1
    v_lshl_add_u32 v59, v63, 2, s8
    ds_write_b32 v59, v45 offset:0
    s_sub_u32 s8, s15, 1
    s_and_b32 s8, s8, 3
    s_and_b32 s10, s3, 4
    s_add_u32 s8, s8, s10
    s_mul_i32 s8, s8, 384
    s_add_u32 s8, s8, 158720
    v_lshl_add_u32 v60, v63, 2, s8
    ds_write_b32 v59, v46 offset:128
    s_sub_u32 s8, s15, 2
    s_and_b32 s8, s8, 3
    s_and_b32 s10, s3, 4
    s_add_u32 s8, s8, s10
    s_mul_i32 s8, s8, 384
    s_add_u32 s8, s8, 158720
    v_lshl_add_u32 v61, v63, 2, s8
    ds_write_b32 v59, v47 offset:256
    s_sub_u32 s8, s15, 3
    s_and_b32 s8, s8, 3
    s_and_b32 s10, s3, 4
    s_add_u32 s8, s8, s10
    s_mul_i32 s8, s8, 384
    s_add_u32 s8, s8, 158720
    v_lshl_add_u32 v62, v63, 2, s8
    v_mov_b32 v10, 1
    s_mov_b64 exec, 1
    ds_add_u32 v58, v10 offset:4
    s_mov_b64 exec, -1
    s_mov_b32 s82, 2097152
L_xss:
    ds_read_b32 v10, v58 offset:4
    s_waitcnt lgkmcnt(0)
    v_cmp_gt_u32 vcc, 4, v10
    s_cbranch_vccz L_xss_ok
    s_sub_u32 s82, s82, 1
    s_cbranch_scc0 L_xss
L_xss_ok:
    ds_read_b128 v[128:131], v49 offset:0
    ds_read_b128 v[132:135], v49 offset:1024
    ds_read_b32 v136, v53 offset:2048
    ds_read_b32 v137, v60 offset:0
    ds_read_b128 v[140:143], v50 offset:2304
    ds_read_b128 v[144:147], v50 offset:3328
    ds_read_b32 v148, v54 offset:4352
    ds_read_b32 v149, v61 offset:128
    ds_read_b128 v[152:155], v51 offset:4608
    ds_read_b128 v[156:159], v51 offset:5632
    ds_read_b32 v160, v55 offset:6656
    ds_read_b32 v161, v62 offset:256
    s_waitcnt lgkmcnt(0)
    v_max3_f32 v10, v44, v137, v149
    v_max_f32 v10, v10, v161
    v_sub_f32 v11, v44, v10
    v_exp_f32 v11, v11
    s_nop 0
    v_mul_f32 v64, v64, v11
    v_mul_f32 v65, v65, v11
    v_mul_f32 v66, v66, v11
    v_mul_f32 v67, v67, v11
    v_mul_f32 v68, v68, v11
    v_mul_f32 v69, v69, v11
    v_mul_f32 v70, v70, v11
    v_mul_f32 v71, v71, v11
    v_mul_f32 v72, v72, v11
    v_sub_f32 v11, v137, v10
    v_exp_f32 v11, v11
    s_nop 0
    v_mul_f32 v128, v128, v11
    v_mul_f32 v129, v129, v11
    v_mul_f32 v130, v130, v11
    v_mul_f32 v131, v131, v11
    v_mul_f32 v132, v132, v11
    v_mul_f32 v133, v133, v11
    v_mul_f32 v134, v134, v11
    v_mul_f32 v135, v135, v11
    v_mul_f32 v136, v136, v11
    v_sub_f32 v11, v149, v10
    v_exp_f32 v11, v11
    s_nop 0
    v_mul_f32 v140, v140, v11
    v_mul_f32 v141, v141, v11
    v_mul_f32 v142, v142, v11
    v_mul_f32 v143, v143, v11
    v_mul_f32 v144, v144, v11
    v_mul_f32 v145, v145, v11
    v_mul_f32 v146, v146, v11
    v_mul_f32 v147, v147, v11
    v_mul_f32 v148, v148, v11
    v_sub_f32 v11, v161, v10
    v_exp_f32 v11, v11
    s_nop 0
    v_mul_f32 v152, v152, v11
    v_mul_f32 v153, v153, v11
    v_mul_f32 v154, v154, v11
    v_mul_f32 v155, v155, v11
    v_mul_f32 v156, v156, v11
    v_mul_f32 v157, v157, v11
    v_mul_f32 v158, v158, v11
    v_mul_f32 v159, v159, v11
    v_mul_f32 v160, v160, v11
    v_add_f32 v72, v72, v136
    v_pk_add_f32 v[64:65], v[64:65], v[128:129]
    v_pk_add_f32 v[66:67], v[66:67], v[130:131]
    v_pk_add_f32 v[68:69], v[68:69], v[132:133]
    v_pk_add_f32 v[70:71], v[70:71], v[134:135]
    v_add_f32 v72, v72, v148
    v_pk_add_f32 v[64:65], v[64:65], v[140:141]
    v_pk_add_f32 v[66:67], v[66:67], v[142:143]
    v_pk_add_f32 v[68:69], v[68:69], v[144:145]
    v_pk_add_f32 v[70:71], v[70:71], v[146:147]
    v_add_f32 v72, v72, v160
    v_pk_add_f32 v[64:65], v[64:65], v[152:153]
    v_pk_add_f32 v[66:67], v[66:67], v[154:155]
    v_pk_add_f32 v[68:69], v[68:69], v[156:157]
    v_pk_add_f32 v[70:71], v[70:71], v[158:159]
    v_rcp_f32 v72, v72
    v_mov_b32 v10, 1
    s_mov_b64 exec, 1
    ds_add_u32 v58, v10 offset:12
    s_mov_b64 exec, -1
    v_pk_mul_f32 v[64:65], v[64:65], v[72:73] op_sel_hi:[1,0]
    v_pk_mul_f32 v[66:67], v[66:67], v[72:73] op_sel_hi:[1,0]
    v_pk_mul_f32 v[68:69], v[68:69], v[72:73] op_sel_hi:[1,0]
    v_pk_mul_f32 v[70:71], v[70:71], v[72:73] op_sel_hi:[1,0]
    v_cvt_pk_bf16_f32 v76, v64, v65
    v_cvt_pk_bf16_f32 v77, v66, v67
    v_cvt_pk_bf16_f32 v78, v68, v69
    v_cvt_pk_bf16_f32 v79, v70, v71
    v_min_u32 v76, -2, v76
    v_min_u32 v77, -2, v77
    v_min_u32 v78, -2, v78
    v_min_u32 v79, -2, v79
    buffer_store_dwordx4 v[76:79], v245, s[68:71], s93 offen sc1
L_last:
    s_branch L_tail
.section .rodata,"a"
.p2align 6
.amdhsa_kernel gated_mix__mha_block__ssm_conv_h3__prompt_kernel
  .amdhsa_next_free_vgpr 256
  .amdhsa_next_free_sgpr 100
  .amdhsa_accum_offset 256
  .amdhsa_group_segment_fixed_size 0
  .amdhsa_kernarg_size 104
  .amdhsa_user_sgpr_count 2
  .amdhsa_user_sgpr_kernarg_segment_ptr 1
  .amdhsa_system_sgpr_workgroup_id_x 1
  .amdhsa_float_denorm_mode_32 3
.end_amdhsa_kernel
```
